```python
import torch

def _softmax(x, axis=-1):
    return torch.softmax(x, dim=axis)
def _gelu(x):
    return torch.nn.functional.gelu(x, approximate="tanh")
def _silu(x):
    return torch.nn.functional.silu(x)
def _sigmoid(x):
    return torch.sigmoid(x)
def _layernorm(x, axis=-1, eps=1e-5):
    m = x.mean(dim=axis, keepdim=True)
    v = x.var(dim=axis, keepdim=True, unbiased=False)
    return (x - m) / torch.sqrt(v + eps)
def _scatter_add(tgt, idx, src, axis=0):
    return tgt.clone().index_add_(axis, idx, src)
def _segment_sum(src, seg, n):
    out = torch.zeros((n,) + src.shape[1:], dtype=src.dtype)
    return out.index_add_(0, seg, src)
def _pad(x, pw):
    flat = tuple(v for pair in reversed(pw) for v in pair)
    return torch.nn.functional.pad(x, flat)

kernel_name = 'recurrent_scan__sliding_block_cached__geglu_ffn__decode'

def setup_inputs():

    _w = (lambda a: (lambda t: t.to(torch.bfloat16) if t.is_floating_point() else t)(torch.as_tensor(a)))
    def _A_setup():
        B, Sq, D = 2, 1, 448
        Hq, Hkv, Sk, Dh = 16, 8, 32768, 256
        assert Hq % Hkv == 0, (Hq, Hkv)
        return {
            "x": _w((lambda *s: torch.randn(*s, dtype=torch.bfloat16) * 0.05)(B, Sq, D)),
            "k_cache": _w((lambda *s: torch.randn(*s, dtype=torch.bfloat16) * 1.6)(B, Hkv, Sk, Dh)),
            "v_cache": _w((lambda *s: torch.randn(*s, dtype=torch.bfloat16) * 0.2)(B, Hkv, Sk, Dh)),
            "wq": _w((lambda *s: torch.randn(*s, dtype=torch.bfloat16) * 1.6)(D, Hq * Dh) * (D ** -0.5)),
            "wo": _w((lambda *s: torch.randn(*s, dtype=torch.bfloat16) * 0.2)(Hq * Dh, D) * ((Hq * Dh) ** -0.5)),
        }
    _A_in = _A_setup()

    def _B_setup():
        B, S, D, F = 2, 1, 448, 1792
        return {
            "x": _w((lambda *s: torch.randn(*s, dtype=torch.bfloat16) * 0.05)(B, S, D)),
            "w_gate": _w((lambda *s: torch.randn(*s, dtype=torch.bfloat16) * 0.1)(D, F)),
            "w_up": _w((lambda *s: torch.randn(*s, dtype=torch.bfloat16) * 0.1)(D, F)),
            "w_down": _w((lambda *s: torch.randn(*s, dtype=torch.bfloat16) * 0.1)(F, D)),
        }
    _B_in = _B_setup()

    return {
        "A_x": _A_in["x"],
        "A_k_cache": _A_in["k_cache"],
        "A_v_cache": _A_in["v_cache"],
        "A_wq": _A_in["wq"],
        "A_wo": _A_in["wo"],
        "B_x": _B_in["x"],
        "B_w_gate": _B_in["w_gate"],
        "B_w_up": _B_in["w_up"],
        "B_w_down": _B_in["w_down"],
    }

def reference(A_x, A_k_cache, A_v_cache, A_wq, A_wo, B_x, B_w_gate, B_w_up, B_w_down):
    def _A_ref(x, k_cache, v_cache, wq, wo):
        B, Sq, D = x.shape
        Hq, Dh = 16, 256
        Hkv, Sk = k_cache.shape[1], k_cache.shape[2]
        W = min(4096, max(256, Sk // 4))
        rep = Hq // Hkv
        q = (lambda x, *d: x.permute(*d))((x @ wq).reshape(B, Sq, Hq, Dh), 0, 2, 1, 3)
        k = (lambda x, n, axis: torch.repeat_interleave(x, n, dim=axis))(k_cache[:, :, Sk - W:, :], rep, axis=1)
        v = (lambda x, n, axis: torch.repeat_interleave(x, n, dim=axis))(v_cache[:, :, Sk - W:, :], rep, axis=1)
        scores = torch.einsum("bhqd,bhkd->bhqk", q, k) * (Dh ** -0.5)
        p = _softmax(scores, axis=-1)
        o = torch.einsum("bhqk,bhkd->bhqd", p, v)
        return (lambda x, *d: x.permute(*d))(o, 0, 2, 1, 3).reshape(B, Sq, Hq * Dh) @ wo

    def _B_ref(x, w_gate, w_up, w_down):
        return (_gelu(x @ w_gate) * (x @ w_up)) @ w_down

    x = A_x
    xn = _layernorm(x, axis=-1)
    s = _A_ref(xn, A_k_cache, A_v_cache, A_wq, A_wo)
    g = _silu(_B_ref(xn, B_w_gate, B_w_up, B_w_down))
    return x + s * g
```

```asm
; @launch grid=(256,1,1) block=(320,1,1) lds=163840
.amdgcn_target "amdgcn-amd-amdhsa--gfx950"
.text
.globl recurrent_scan__sliding_block_cached__geglu_ffn__decode_kernel
.p2align 8
.type recurrent_scan__sliding_block_cached__geglu_ffn__decode_kernel,@function
recurrent_scan__sliding_block_cached__geglu_ffn__decode_kernel:
  s_cmp_ge_u32 s2, 256
  s_cbranch_scc1 L_exit
  s_load_dwordx8 s[4:11], s[0:1], 0
  s_load_dwordx2 s[12:13], s[0:1], 32
  s_load_dwordx4 s[16:19], s[0:1], 48
  s_load_dwordx4 s[20:23], s[0:1], 64
  s_load_dwordx2 s[24:25], s[0:1], 88
  v_lshrrev_b32 v1, 6, v0
  v_and_b32 v0, 63, v0
  s_and_b32 s26, s2, 7
  v_readfirstlane_b32 s30, v1
  s_lshr_b32 s27, s2, 3
  s_lshr_b32 s28, s27, 4
  s_and_b32 s29, s27, 15
  s_cmp_lt_u32 s27, 28
  s_cselect_b32 s34, 14, 0
  s_cselect_b32 s36, 16, 0
  s_cselect_b32 s35, 8, 0
  s_cmp_lt_u32 s26, 7
  s_cselect_b32 s35, s35, 0
  s_cselect_b32 s34, 14, 0
  s_mov_b32 s58, 0
  s_add_u32 s37, s34, 14
  s_add_u32 s38, s37, s35
  s_add_u32 s38, s38, s58
  s_add_u32 s38, s38, 128
  s_mul_i32 s50, s27, 37
  s_lshr_b32 s50, s50, 8
  s_mul_i32 s41, s50, 7
  s_sub_u32 s51, s27, s41
  s_lshr_b32 s41, s27, 3
  s_lshl_b32 s42, s26, 2
  s_add_u32 s14, s41, s42
  s_and_b32 s15, s27, 7
  s_add_u32 s3, s42, s50
  s_mov_b32 s96, s51
  s_lshl_b32 s52, s26, 2
  s_add_u32 s52, s52, s27
  s_sub_u32 s52, s52, 28
  s_mov_b32 s40, 2097152
  s_mov_b32 s60, 0xC0000000
  s_cmp_eq_u32 s30, 0
  s_cbranch_scc0 L_compute
  s_setprio 3
  v_lshlrev_b32 v16, 2, v0
  v_add_u32 v16, 162944, v16
  v_mov_b32 v5, 0xC0000000
  ds_write_b32 v16, v5
  v_mov_b32 v17, 162880
  v_mov_b32 v6, 0
  v_mov_b32 v7, 0
  v_mov_b32 v8, 0
  v_mov_b32 v9, 0
  ds_write_b128 v17, v[6:9]
  v_lshrrev_b32 v2, 3, v0
  v_and_b32 v3, 7, v0
  v_lshrrev_b32 v4, 4, v0
  v_lshlrev_b32 v4, 1, v4
  v_xor_b32 v3, v3, v4
  v_lshlrev_b32 v3, 4, v3
  v_lshl_add_u32 v5, v2, 13, v3
  s_lshr_b32 s41, s27, 3
  s_mul_i32 s41, s41, 917504
  s_lshl_b32 s42, s26, 10
  s_add_u32 s41, s41, s42
  s_and_b32 s42, s27, 7
  s_lshl_b32 s42, s42, 7
  s_add_u32 s41, s41, s42
  s_mov_b32 m0, 131072
  s_mov_b32 s46, 14
  s_waitcnt lgkmcnt(0)
  s_add_u32 s44, s10, s41
  s_addc_u32 s45, s11, 0
WQ_1:
  global_load_lds_dwordx4 v5, s[44:45] nt
  s_add_u32 s44, s44, 65536
  s_addc_u32 s45, s45, 0
  s_add_u32 m0, m0, 1024
  s_sub_u32 s46, s46, 1
  s_cmp_lg_u32 s46, 0
  s_cbranch_scc1 WQ_1
  v_mul_u32_u24 v6, 3584, v2
  v_add_u32 v6, v6, v3
  v_mul_u32_u24 v7, 896, v2
  v_add_u32 v7, v7, v3
  s_cmp_eq_u32 s34, 0
  s_cbranch_scc1 NOGU_2
  s_and_b32 s41, s15, 1
  s_cmp_eq_u32 s41, 0
  s_cselect_b32 s44, s16, s18
  s_cselect_b32 s45, s17, s19
  s_lshr_b32 s41, s15, 1
  s_mul_i32 s41, s41, 401408
  s_lshl_b32 s42, s14, 7
  s_add_u32 s41, s41, s42
  s_add_u32 s44, s44, s41
  s_addc_u32 s45, s45, 0
  s_mov_b32 m0, 145408
  s_mov_b32 s46, 14
GU_3:
  global_load_lds_dwordx4 v6, s[44:45] nt
  s_add_u32 s44, s44, 28672
  s_addc_u32 s45, s45, 0
  s_add_u32 m0, m0, 1024
  s_sub_u32 s46, s46, 1
  s_cmp_lg_u32 s46, 0
  s_cbranch_scc1 GU_3
NOGU_2:
  v_lshrrev_b32 v8, 5, v0
  v_and_b32 v9, 31, v0
  v_lshlrev_b32 v10, 1, v8
  v_xor_b32 v9, v9, v10
  v_lshlrev_b32 v9, 4, v9
  v_lshlrev_b32 v8, 9, v8
  v_xor_b32 v12, 0, v9
  v_add_u32 v12, v12, v8
  v_xor_b32 v13, 64, v9
  v_add_u32 v13, v13, v8
  v_xor_b32 v14, 128, v9
  v_add_u32 v14, v14, v8
  v_xor_b32 v15, 192, v9
  v_add_u32 v15, v15, v8
  s_lshl_b32 s41, s28, 3
  s_add_u32 s41, s41, s26
  s_lshl_b32 s41, s41, 24
  s_add_u32 s41, s41, 14680064
  s_lshl_b32 s42, s29, 13
  s_add_u32 s41, s41, s42
  s_add_u32 s44, s6, s41
  s_addc_u32 s45, s7, 0
  s_add_u32 s48, s8, s41
  s_addc_u32 s49, s9, 0
  s_add_u32 s47, s34, 14
  s_mov_b32 m0, 0
  s_nop 0
  global_load_lds_dwordx4 v12, s[44:45] offset:0 nt
  global_load_lds_dwordx4 v13, s[44:45] offset:1024 nt
  global_load_lds_dwordx4 v14, s[44:45] offset:2048 nt
  global_load_lds_dwordx4 v15, s[44:45] offset:3072 nt
  s_add_u32 s44, s44, 4096
  s_addc_u32 s45, s45, 0
  s_add_u32 m0, m0, 4096
  s_nop 0
  global_load_lds_dwordx4 v12, s[44:45] offset:0 nt
  global_load_lds_dwordx4 v13, s[44:45] offset:1024 nt
  global_load_lds_dwordx4 v14, s[44:45] offset:2048 nt
  global_load_lds_dwordx4 v15, s[44:45] offset:3072 nt
  s_add_u32 s44, s44, 126976
  s_addc_u32 s45, s45, 0
  s_add_u32 m0, m0, 4096
  s_add_u32 s47, s47, 8
  s_barrier
  s_cmp_eq_u32 s34, 0
  s_cbranch_scc0 HASGU_4
  s_waitcnt vmcnt(8)
  s_sub_u32 s46, s47, 8
  v_mov_b32 v18, s46
  ds_write_b32 v16, v18
  global_load_lds_dwordx4 v12, s[44:45] offset:0 nt
  global_load_lds_dwordx4 v13, s[44:45] offset:1024 nt
  global_load_lds_dwordx4 v14, s[44:45] offset:2048 nt
  global_load_lds_dwordx4 v15, s[44:45] offset:3072 nt
  s_add_u32 s44, s44, 4096
  s_addc_u32 s45, s45, 0
  s_add_u32 m0, m0, 4096
  s_nop 0
  global_load_lds_dwordx4 v12, s[44:45] offset:0 nt
  global_load_lds_dwordx4 v13, s[44:45] offset:1024 nt
  global_load_lds_dwordx4 v14, s[44:45] offset:2048 nt
  global_load_lds_dwordx4 v15, s[44:45] offset:3072 nt
  s_add_u32 s44, s44, 126976
  s_addc_u32 s45, s45, 0
  s_add_u32 m0, m0, 4096
  s_add_u32 s47, s47, 8
  s_branch J_5
HASGU_4:
  s_waitcnt vmcnt(22)
  s_sub_u32 s46, s47, 22
  v_mov_b32 v18, s46
  ds_write_b32 v16, v18
  global_load_lds_dwordx4 v12, s[44:45] offset:0 nt
  global_load_lds_dwordx4 v13, s[44:45] offset:1024 nt
  global_load_lds_dwordx4 v14, s[44:45] offset:2048 nt
  global_load_lds_dwordx4 v15, s[44:45] offset:3072 nt
  s_add_u32 s44, s44, 4096
  s_addc_u32 s45, s45, 0
  s_add_u32 m0, m0, 4096
  s_nop 0
  global_load_lds_dwordx4 v12, s[44:45] offset:0 nt
  global_load_lds_dwordx4 v13, s[44:45] offset:1024 nt
  global_load_lds_dwordx4 v14, s[44:45] offset:2048 nt
  global_load_lds_dwordx4 v15, s[44:45] offset:3072 nt
  s_add_u32 s44, s44, 126976
  s_addc_u32 s45, s45, 0
  s_add_u32 m0, m0, 4096
  s_add_u32 s47, s47, 8
  s_waitcnt vmcnt(16)
  s_sub_u32 s46, s47, 16
  v_mov_b32 v18, s46
  ds_write_b32 v16, v18
J_5:
  s_mov_b32 s43, 6
KL_6:
  global_load_lds_dwordx4 v12, s[44:45] offset:0 nt
  global_load_lds_dwordx4 v13, s[44:45] offset:1024 nt
  global_load_lds_dwordx4 v14, s[44:45] offset:2048 nt
  global_load_lds_dwordx4 v15, s[44:45] offset:3072 nt
  s_add_u32 s44, s44, 4096
  s_addc_u32 s45, s45, 0
  s_add_u32 m0, m0, 4096
  s_nop 0
  global_load_lds_dwordx4 v12, s[44:45] offset:0 nt
  global_load_lds_dwordx4 v13, s[44:45] offset:1024 nt
  global_load_lds_dwordx4 v14, s[44:45] offset:2048 nt
  global_load_lds_dwordx4 v15, s[44:45] offset:3072 nt
  s_add_u32 s44, s44, 126976
  s_addc_u32 s45, s45, 0
  s_add_u32 m0, m0, 4096
  s_add_u32 s47, s47, 8
  s_waitcnt vmcnt(40)
  s_sub_u32 s46, s47, 40
  v_mov_b32 v18, s46
  ds_write_b32 v16, v18
  s_sub_u32 s43, s43, 1
  s_cmp_lg_u32 s43, 0
  s_cbranch_scc1 KL_6
  s_cmp_eq_u32 s58, 0
  s_cbranch_scc1 NOG2_7
  s_cmp_ge_i32 s60, 1
  s_cbranch_scc1 WPX_9
WP_8:
  ds_read_b128 v[20:23], v17
  s_waitcnt lgkmcnt(0)
  v_min3_i32 v20, v20, v21, v22
  v_min_i32 v20, v20, v23
  s_nop 0
  v_readfirstlane_b32 s60, v20
  s_nop 0
  s_cmp_ge_i32 s60, 1
  s_cbranch_scc1 WPX_9
  s_cmp_eq_u32 s40, 0
  s_cbranch_scc1 WPX_9
  s_sub_u32 s40, s40, 1
  s_branch WP_8
WPX_9:
  s_mov_b32 s42, m0
  s_lshr_b32 s41, s26, 1
  s_mul_i32 s41, s41, 401408
  s_lshl_b32 s46, s27, 7
  s_add_u32 s41, s41, s46
  s_add_u32 s62, s18, s41
  s_addc_u32 s63, s19, 0
  s_mov_b32 m0, 131072
  s_mov_b32 s46, 14
G2_10:
  global_load_lds_dwordx4 v6, s[62:63] nt
  s_add_u32 s62, s62, 28672
  s_addc_u32 s63, s63, 0
  s_add_u32 m0, m0, 1024
  s_sub_u32 s46, s46, 1
  s_cmp_lg_u32 s46, 0
  s_cbranch_scc1 G2_10
  s_mov_b32 m0, s42
  s_add_u32 s47, s47, 14
  s_waitcnt vmcnt(16)
  s_sub_u32 s46, s47, 16
  v_mov_b32 v18, s46
  ds_write_b32 v16, v18
NOG2_7:
  s_mov_b32 s43, 8
KL_11:
  global_load_lds_dwordx4 v12, s[44:45] offset:0 nt
  global_load_lds_dwordx4 v13, s[44:45] offset:1024 nt
  global_load_lds_dwordx4 v14, s[44:45] offset:2048 nt
  global_load_lds_dwordx4 v15, s[44:45] offset:3072 nt
  s_add_u32 s44, s44, 4096
  s_addc_u32 s45, s45, 0
  s_add_u32 m0, m0, 4096
  s_nop 0
  global_load_lds_dwordx4 v12, s[44:45] offset:0 nt
  global_load_lds_dwordx4 v13, s[44:45] offset:1024 nt
  global_load_lds_dwordx4 v14, s[44:45] offset:2048 nt
  global_load_lds_dwordx4 v15, s[44:45] offset:3072 nt
  s_add_u32 s44, s44, 126976
  s_addc_u32 s45, s45, 0
  s_add_u32 m0, m0, 4096
  s_add_u32 s47, s47, 8
  s_waitcnt vmcnt(40)
  s_sub_u32 s46, s47, 40
  v_mov_b32 v18, s46
  ds_write_b32 v16, v18
  s_sub_u32 s43, s43, 1
  s_cmp_lg_u32 s43, 0
  s_cbranch_scc1 KL_11
  s_cmp_eq_u32 s35, 0
  s_cbranch_scc1 NOWD_12
  s_cmp_ge_i32 s60, 4
  s_cbranch_scc1 WPX_14
WP_13:
  ds_read_b128 v[20:23], v17
  s_waitcnt lgkmcnt(0)
  v_min3_i32 v20, v20, v21, v22
  v_min_i32 v20, v20, v23
  s_nop 0
  v_readfirstlane_b32 s60, v20
  s_nop 0
  s_cmp_ge_i32 s60, 4
  s_cbranch_scc1 WPX_14
  s_cmp_eq_u32 s40, 0
  s_cbranch_scc1 WPX_14
  s_sub_u32 s40, s40, 1
  s_branch WP_13
WPX_14:
  s_mul_i32 s41, s3, 57344
  s_lshl_b32 s42, s96, 7
  s_add_u32 s41, s41, s42
  s_add_u32 s62, s20, s41
  s_addc_u32 s63, s21, 0
  s_mov_b32 m0, 131072
  s_mov_b32 s46, 8
RW_15:
  global_load_lds_dwordx4 v7, s[62:63] nt
  s_add_u32 s62, s62, 7168
  s_addc_u32 s63, s63, 0
  s_add_u32 m0, m0, 1024
  s_sub_u32 s46, s46, 1
  s_cmp_lg_u32 s46, 0
  s_cbranch_scc1 RW_15
  s_add_u32 s47, s47, 8
  s_waitcnt vmcnt(16)
  s_sub_u32 s46, s47, 16
  v_mov_b32 v18, s46
  ds_write_b32 v16, v18
NOWD_12:
  s_mov_b32 m0, 0
  s_mov_b32 s43, 0
VL_16:
  s_lshr_b32 s41, s43, 2
  s_lshr_b32 s42, s43, 3
  s_add_u32 s41, s41, s42
  s_add_u32 s41, s41, 2
  s_cmp_ge_i32 s60, s41
  s_cbranch_scc1 WPX_18
WP_17:
  ds_read_b128 v[20:23], v17
  s_waitcnt lgkmcnt(0)
  v_min3_i32 v20, v20, v21, v22
  v_min_i32 v20, v20, v23
  s_nop 0
  v_readfirstlane_b32 s60, v20
  s_nop 0
  s_cmp_ge_i32 s60, s41
  s_cbranch_scc1 WPX_18
  s_cmp_eq_u32 s40, 0
  s_cbranch_scc1 WPX_18
  s_sub_u32 s40, s40, 1
  s_branch WP_17
WPX_18:
  global_load_lds_dwordx4 v12, s[48:49] offset:0 nt
  global_load_lds_dwordx4 v13, s[48:49] offset:1024 nt
  global_load_lds_dwordx4 v14, s[48:49] offset:2048 nt
  global_load_lds_dwordx4 v15, s[48:49] offset:3072 nt
  s_add_u32 s48, s48, 4096
  s_addc_u32 s49, s49, 0
  s_add_u32 m0, m0, 4096
  s_nop 0
  global_load_lds_dwordx4 v12, s[48:49] offset:0 nt
  global_load_lds_dwordx4 v13, s[48:49] offset:1024 nt
  global_load_lds_dwordx4 v14, s[48:49] offset:2048 nt
  global_load_lds_dwordx4 v15, s[48:49] offset:3072 nt
  s_add_u32 s48, s48, 126976
  s_addc_u32 s49, s49, 0
  s_add_u32 m0, m0, 4096
  s_add_u32 s47, s47, 8
  s_waitcnt vmcnt(16)
  s_sub_u32 s46, s47, 16
  v_mov_b32 v18, s46
  ds_write_b32 v16, v18
  s_add_u32 s43, s43, 1
  s_cmp_lg_u32 s43, 16
  s_cbranch_scc1 VL_16
  s_cmp_eq_u32 s36, 0
  s_cbranch_scc1 NOWO_19
  s_lshl_b32 s41, s26, 2
  s_add_u32 s41, s41, s50
  s_mul_i32 s41, s41, 114688
  s_lshl_b32 s42, s51, 7
  s_add_u32 s41, s41, s42
  s_add_u32 s62, s12, s41
  s_addc_u32 s63, s13, 0
  s_mov_b32 m0, 139264
  s_mov_b32 s46, 16
RW_22:
  global_load_lds_dwordx4 v7, s[62:63] nt
  s_add_u32 s62, s62, 7168
  s_addc_u32 s63, s63, 0
  s_add_u32 m0, m0, 1024
  s_sub_u32 s46, s46, 1
  s_cmp_lg_u32 s46, 0
  s_cbranch_scc1 RW_22
  s_add_u32 s47, s47, 16
  s_waitcnt vmcnt(24)
  s_sub_u32 s46, s47, 24
  v_mov_b32 v18, s46
  ds_write_b32 v16, v18
  s_waitcnt vmcnt(16)
  s_barrier
  s_waitcnt vmcnt(0)
  s_sub_u32 s46, s47, 0
  v_mov_b32 v18, s46
  ds_write_b32 v16, v18
  s_branch LDONE_20
NOWO_19:
  s_waitcnt vmcnt(8)
  s_sub_u32 s46, s47, 8
  v_mov_b32 v18, s46
  ds_write_b32 v16, v18
  s_waitcnt vmcnt(0)
  s_barrier
LDONE_20:
  s_waitcnt lgkmcnt(0)
  s_endpgm
L_compute:
  s_sub_u32 s31, s30, 1
  v_min_u32 v3, 55, v0
  v_lshlrev_b32 v3, 4, v3
  v_and_b32 v1, 15, v0
  v_lshrrev_b32 v2, 4, v0
  s_mov_b32 s39, 1023
  s_mov_b32 s57, 0xffff0000
  s_mov_b32 s54, 0x00030003
  s_mov_b32 s55, 0x00030003
  s_mov_b32 s56, 0x3db8aa3b
  s_waitcnt lgkmcnt(0)
  global_load_dwordx4 v[24:27], v3, s[4:5]
  global_load_dwordx4 v[28:31], v3, s[4:5] offset:896
  s_load_dwordx2 s[32:33], s[24:25], 0
  v_mov_b32 v16, 512
  v_mov_b32 v18, 162880
  v_mov_b32 v19, 162944
  v_lshlrev_b32 v4, 2, v0
  v_add_u32 v4, 163200, v4
  s_lshl_b32 s41, s31, 2
  s_add_u32 s41, s41, 162880
  v_mov_b32 v5, s41
  v_cmp_eq_u32 vcc, 0, v0
  s_nop 1
  v_cndmask_b32 v17, v4, v5, vcc
  v_lshrrev_b32 v4, 2, v1
  v_lshl_add_u32 v4, v2, 2, v4
  v_lshrrev_b32 v5, 1, v4
  v_and_b32 v5, 3, v5
  v_xor_b32 v5, s31, v5
  v_lshlrev_b32 v5, 5, v5
  v_lshl_add_u32 v5, v4, 7, v5
  v_and_b32 v6, 3, v1
  v_lshl_add_u32 v5, v6, 3, v5
  v_add_u32 v20, 131072, v5
  s_barrier
  v_cmp_gt_u32 vcc, 56, v0
  s_waitcnt vmcnt(0)
  s_nop 0
  v_cndmask_b32 v24, 0, v24, vcc
  v_cndmask_b32 v25, 0, v25, vcc
  v_cndmask_b32 v26, 0, v26, vcc
  v_cndmask_b32 v27, 0, v27, vcc
  v_cndmask_b32 v28, 0, v28, vcc
  v_cndmask_b32 v29, 0, v29, vcc
  v_cndmask_b32 v30, 0, v30, vcc
  v_cndmask_b32 v31, 0, v31, vcc
  v_lshlrev_b32 v32, 16, v24
  v_and_b32 v33, s57, v24
  v_lshlrev_b32 v34, 16, v25
  v_and_b32 v35, s57, v25
  v_lshlrev_b32 v36, 16, v26
  v_and_b32 v37, s57, v26
  v_lshlrev_b32 v38, 16, v27
  v_and_b32 v39, s57, v27
  v_lshlrev_b32 v40, 16, v28
  v_and_b32 v41, s57, v28
  v_lshlrev_b32 v42, 16, v29
  v_and_b32 v43, s57, v29
  v_lshlrev_b32 v44, 16, v30
  v_and_b32 v45, s57, v30
  v_lshlrev_b32 v46, 16, v31
  v_and_b32 v47, s57, v31
  v_add_f32 v48, v32, v33
  v_add_f32 v48, v48, v34
  v_add_f32 v48, v48, v35
  v_add_f32 v48, v48, v36
  v_add_f32 v48, v48, v37
  v_add_f32 v48, v48, v38
  v_add_f32 v48, v48, v39
  v_add_f32 v49, v40, v41
  v_add_f32 v49, v49, v42
  v_add_f32 v49, v49, v43
  v_add_f32 v49, v49, v44
  v_add_f32 v49, v49, v45
  v_add_f32 v49, v49, v46
  v_add_f32 v49, v49, v47
  v_add_f32_dpp v48, v48, v48 row_ror:8 row_mask:0xf bank_mask:0xf
  s_nop 0
  v_add_f32_dpp v49, v49, v49 row_ror:8 row_mask:0xf bank_mask:0xf
  v_add_f32_dpp v48, v48, v48 row_ror:4 row_mask:0xf bank_mask:0xf
  s_nop 0
  v_add_f32_dpp v49, v49, v49 row_ror:4 row_mask:0xf bank_mask:0xf
  v_add_f32_dpp v48, v48, v48 row_ror:2 row_mask:0xf bank_mask:0xf
  s_nop 0
  v_add_f32_dpp v49, v49, v49 row_ror:2 row_mask:0xf bank_mask:0xf
  v_add_f32_dpp v48, v48, v48 row_ror:1 row_mask:0xf bank_mask:0xf
  s_nop 0
  v_add_f32_dpp v49, v49, v49 row_ror:1 row_mask:0xf bank_mask:0xf
  v_mov_b32 v50, v48
  v_mov_b32 v51, v49
  s_nop 0
  v_permlane16_swap_b32 v48, v50
  v_permlane16_swap_b32 v49, v51
  v_add_f32 v48, v48, v50
  v_add_f32 v49, v49, v51
  v_mov_b32 v50, v48
  v_mov_b32 v51, v49
  s_nop 0
  v_permlane32_swap_b32 v48, v50
  v_permlane32_swap_b32 v49, v51
  v_add_f32 v48, v48, v50
  v_add_f32 v49, v49, v51
  v_mov_b32 v4, 0x3b124925
  v_mul_f32 v48, v48, v4
  v_mul_f32 v49, v49, v4
  v_sub_f32 v5, v32, v48
  v_mul_f32 v52, v5, v5
  v_sub_f32 v5, v33, v48
  v_fma_f32 v52, v5, v5, v52
  v_sub_f32 v5, v34, v48
  v_fma_f32 v52, v5, v5, v52
  v_sub_f32 v5, v35, v48
  v_fma_f32 v52, v5, v5, v52
  v_sub_f32 v5, v36, v48
  v_fma_f32 v52, v5, v5, v52
  v_sub_f32 v5, v37, v48
  v_fma_f32 v52, v5, v5, v52
  v_sub_f32 v5, v38, v48
  v_fma_f32 v52, v5, v5, v52
  v_sub_f32 v5, v39, v48
  v_fma_f32 v52, v5, v5, v52
  v_sub_f32 v5, v40, v49
  v_mul_f32 v53, v5, v5
  v_sub_f32 v5, v41, v49
  v_fma_f32 v53, v5, v5, v53
  v_sub_f32 v5, v42, v49
  v_fma_f32 v53, v5, v5, v53
  v_sub_f32 v5, v43, v49
  v_fma_f32 v53, v5, v5, v53
  v_sub_f32 v5, v44, v49
  v_fma_f32 v53, v5, v5, v53
  v_sub_f32 v5, v45, v49
  v_fma_f32 v53, v5, v5, v53
  v_sub_f32 v5, v46, v49
  v_fma_f32 v53, v5, v5, v53
  v_sub_f32 v5, v47, v49
  v_fma_f32 v53, v5, v5, v53
  v_cndmask_b32 v52, 0, v52, vcc
  v_cndmask_b32 v53, 0, v53, vcc
  s_nop 0
  v_add_f32_dpp v52, v52, v52 row_ror:8 row_mask:0xf bank_mask:0xf
  v_add_f32_dpp v53, v53, v53 row_ror:8 row_mask:0xf bank_mask:0xf
  s_nop 0
  v_add_f32_dpp v52, v52, v52 row_ror:4 row_mask:0xf bank_mask:0xf
  v_add_f32_dpp v53, v53, v53 row_ror:4 row_mask:0xf bank_mask:0xf
  s_nop 0
  v_add_f32_dpp v52, v52, v52 row_ror:2 row_mask:0xf bank_mask:0xf
  v_add_f32_dpp v53, v53, v53 row_ror:2 row_mask:0xf bank_mask:0xf
  s_nop 0
  v_add_f32_dpp v52, v52, v52 row_ror:1 row_mask:0xf bank_mask:0xf
  v_add_f32_dpp v53, v53, v53 row_ror:1 row_mask:0xf bank_mask:0xf
  v_mov_b32 v54, v52
  v_mov_b32 v55, v53
  s_nop 0
  v_permlane16_swap_b32 v52, v54
  v_permlane16_swap_b32 v53, v55
  v_add_f32 v52, v52, v54
  v_add_f32 v53, v53, v55
  v_mov_b32 v54, v52
  v_mov_b32 v55, v53
  s_nop 0
  v_permlane32_swap_b32 v52, v54
  v_permlane32_swap_b32 v53, v55
  v_add_f32 v52, v52, v54
  v_add_f32 v53, v53, v55
  v_mul_f32 v52, v52, v4
  v_cvt_pk_bf16_f32 v52, v52, v52
  v_and_b32 v52, s57, v52
  v_add_f32 v52, 0x3727c5ac, v52
  v_cvt_pk_bf16_f32 v52, v52, v52
  v_and_b32 v52, s57, v52
  v_sqrt_f32 v52, v52
  s_nop 0
  v_cvt_pk_bf16_f32 v52, v52, v52
  v_and_b32 v52, s57, v52
  v_rcp_f32 v52, v52
  v_cvt_pk_bf16_f32 v48, v48, v48
  v_and_b32 v48, s57, v48
  v_mul_f32 v53, v53, v4
  v_cvt_pk_bf16_f32 v53, v53, v53
  v_and_b32 v53, s57, v53
  v_add_f32 v53, 0x3727c5ac, v53
  v_cvt_pk_bf16_f32 v53, v53, v53
  v_and_b32 v53, s57, v53
  v_sqrt_f32 v53, v53
  s_nop 0
  v_cvt_pk_bf16_f32 v53, v53, v53
  v_and_b32 v53, s57, v53
  v_rcp_f32 v53, v53
  v_cvt_pk_bf16_f32 v49, v49, v49
  v_and_b32 v49, s57, v49
  v_sub_f32 v32, v32, v48
  v_sub_f32 v33, v33, v48
  v_cvt_pk_bf16_f32 v5, v32, v33
  v_lshlrev_b32 v32, 16, v5
  v_and_b32 v33, s57, v5
  v_mul_f32 v32, v32, v52
  v_mul_f32 v33, v33, v52
  v_cvt_pk_bf16_f32 v24, v32, v33
  v_sub_f32 v34, v34, v48
  v_sub_f32 v35, v35, v48
  v_cvt_pk_bf16_f32 v5, v34, v35
  v_lshlrev_b32 v34, 16, v5
  v_and_b32 v35, s57, v5
  v_mul_f32 v34, v34, v52
  v_mul_f32 v35, v35, v52
  v_cvt_pk_bf16_f32 v25, v34, v35
  v_sub_f32 v36, v36, v48
  v_sub_f32 v37, v37, v48
  v_cvt_pk_bf16_f32 v5, v36, v37
  v_lshlrev_b32 v36, 16, v5
  v_and_b32 v37, s57, v5
  v_mul_f32 v36, v36, v52
  v_mul_f32 v37, v37, v52
  v_cvt_pk_bf16_f32 v26, v36, v37
  v_sub_f32 v38, v38, v48
  v_sub_f32 v39, v39, v48
  v_cvt_pk_bf16_f32 v5, v38, v39
  v_lshlrev_b32 v38, 16, v5
  v_and_b32 v39, s57, v5
  v_mul_f32 v38, v38, v52
  v_mul_f32 v39, v39, v52
  v_cvt_pk_bf16_f32 v27, v38, v39
  v_sub_f32 v40, v40, v49
  v_sub_f32 v41, v41, v49
  v_cvt_pk_bf16_f32 v5, v40, v41
  v_lshlrev_b32 v40, 16, v5
  v_and_b32 v41, s57, v5
  v_mul_f32 v40, v40, v53
  v_mul_f32 v41, v41, v53
  v_cvt_pk_bf16_f32 v28, v40, v41
  v_sub_f32 v42, v42, v49
  v_sub_f32 v43, v43, v49
  v_cvt_pk_bf16_f32 v5, v42, v43
  v_lshlrev_b32 v42, 16, v5
  v_and_b32 v43, s57, v5
  v_mul_f32 v42, v42, v53
  v_mul_f32 v43, v43, v53
  v_cvt_pk_bf16_f32 v29, v42, v43
  v_sub_f32 v44, v44, v49
  v_sub_f32 v45, v45, v49
  v_cvt_pk_bf16_f32 v5, v44, v45
  v_lshlrev_b32 v44, 16, v5
  v_and_b32 v45, s57, v5
  v_mul_f32 v44, v44, v53
  v_mul_f32 v45, v45, v53
  v_cvt_pk_bf16_f32 v30, v44, v45
  v_sub_f32 v46, v46, v49
  v_sub_f32 v47, v47, v49
  v_cvt_pk_bf16_f32 v5, v46, v47
  v_lshlrev_b32 v46, 16, v5
  v_and_b32 v47, s57, v5
  v_mul_f32 v46, v46, v53
  v_mul_f32 v47, v47, v53
  v_cvt_pk_bf16_f32 v31, v46, v47
  v_lshlrev_b32 v4, 4, v0
  v_add_u32 v4, 159744, v4
  s_mov_b32 exec_hi, 0x00ffffff
  ds_write_b128 v4, v[24:27]
  ds_write_b128 v4, v[28:31] offset:896
  s_mov_b64 exec, -1
  s_waitcnt lgkmcnt(0)
  s_add_u32 s32, s32, 1
  s_and_b32 s41, s32, s39
  v_mov_b32 v12, s41
  s_lshr_b32 s41, s32, 10
  s_and_b32 s41, s41, s39
  v_mov_b32 v13, s41
  s_lshr_b32 s41, s32, 20
  s_and_b32 s41, s41, s39
  v_mov_b32 v14, s41
  s_lshr_b32 s41, s32, 30
  s_lshl_b32 s42, s33, 2
  s_or_b32 s41, s41, s42
  s_and_b32 s41, s41, s39
  v_mov_b32 v15, s41
  v_and_b32 v4, 1, v1
  v_mul_u32_u24 v4, 896, v4
  v_lshl_add_u32 v4, v2, 3, v4
  v_add_u32 v3, 159744, v4
  s_lshr_b32 s41, s27, 3
  s_mul_i32 s41, s41, 224
  v_add_u32 v4, s41, v3
  v_lshlrev_b32 v5, 8, v1
  v_lshl_add_u32 v5, v2, 4, v5
  s_lshl_b32 s41, s31, 6
  v_add_u32 v5, s41, v5
  s_lshl_b32 s41, s26, 14
  s_lshl_b32 s42, s27, 9
  s_add_u32 s41, s41, s42
  s_add_u32 s41, s41, 4096
  v_add_u32 v6, s41, v5
  s_cmp_ge_i32 s60, 14
  s_cbranch_scc1 WLX_24
WL_23:
  ds_read_b32 v21, v19
  s_waitcnt lgkmcnt(0)
  v_readfirstlane_b32 s60, v21
  s_nop 0
  s_cmp_ge_i32 s60, 14
  s_cbranch_scc1 WLX_24
  s_cmp_eq_u32 s40, 0
  s_cbranch_scc1 WLX_24
  s_sub_u32 s40, s40, 1
  s_branch WL_23
WLX_24:
  ds_read_b64_tr_b16 v[24:25], v20 offset:0
  ds_read_b64 v[26:27], v4 offset:0
  ds_read_b64_tr_b16 v[28:29], v20 offset:2048
  ds_read_b64 v[30:31], v4 offset:32
  ds_read_b64_tr_b16 v[32:33], v20 offset:4096
  ds_read_b64 v[34:35], v4 offset:64
  ds_read_b64_tr_b16 v[36:37], v20 offset:6144
  ds_read_b64 v[38:39], v4 offset:96
  ds_read_b64_tr_b16 v[40:41], v20 offset:8192
  ds_read_b64 v[42:43], v4 offset:128
  ds_read_b64_tr_b16 v[44:45], v20 offset:10240
  ds_read_b64 v[46:47], v4 offset:160
  ds_read_b64_tr_b16 v[48:49], v20 offset:12288
  ds_read_b64 v[50:51], v4 offset:192
  s_waitcnt lgkmcnt(12)
  v_mfma_f32_16x16x16_bf16 v[56:59], v[24:25], v[26:27], 0
  s_waitcnt lgkmcnt(10)
  v_mfma_f32_16x16x16_bf16 v[56:59], v[28:29], v[30:31], v[56:59]
  s_waitcnt lgkmcnt(8)
  v_mfma_f32_16x16x16_bf16 v[56:59], v[32:33], v[34:35], v[56:59]
  s_waitcnt lgkmcnt(6)
  v_mfma_f32_16x16x16_bf16 v[56:59], v[36:37], v[38:39], v[56:59]
  s_waitcnt lgkmcnt(4)
  v_mfma_f32_16x16x16_bf16 v[56:59], v[40:41], v[42:43], v[56:59]
  s_waitcnt lgkmcnt(2)
  v_mfma_f32_16x16x16_bf16 v[56:59], v[44:45], v[46:47], v[56:59]
  s_waitcnt lgkmcnt(0)
  v_mfma_f32_16x16x16_bf16 v[56:59], v[48:49], v[50:51], v[56:59]
  s_nop 7
  v_bfi_b32 v56, s39, v12, v56
  v_bfi_b32 v57, s39, v13, v57
  v_bfi_b32 v58, s39, v14, v58
  v_bfi_b32 v59, s39, v15, v59
  s_mov_b64 exec, s[54:55]
  global_store_dwordx4 v6, v[56:59], s[24:25] sc1
  s_mov_b64 exec, -1
  v_mov_b32 v21, 1
  ds_write_b32 v17, v21
  s_getreg_b32 s53, hwreg(HW_REG_XCC_ID)
  s_and_b32 s53, s53, 15
  s_cmp_lg_u32 s31, 0
  s_cbranch_scc1 NOXC_25
  s_lshl_b32 s41, s53, 16
  v_mov_b32 v56, s41
  v_mov_b32 v57, s41
  v_mov_b32 v58, s41
  v_mov_b32 v59, s41
  v_bfi_b32 v56, s39, v12, v56
  v_bfi_b32 v57, s39, v13, v57
  v_bfi_b32 v58, s39, v14, v58
  v_bfi_b32 v59, s39, v15, v59
  s_lshl_b32 s41, s26, 9
  s_lshl_b32 s42, s27, 4
  s_add_u32 s41, s41, s42
  s_add_u32 s41, s41, 258048
  v_mov_b32 v7, s41
  s_mov_b64 exec, 1
  global_store_dwordx4 v7, v[56:59], s[24:25] sc1
  s_mov_b64 exec, -1
NOXC_25:
  s_cmp_eq_u32 s34, 0
  s_cbranch_scc1 NOGU_26
  s_lshr_b32 s41, s15, 1
  s_mul_i32 s41, s41, 224
  v_add_u32 v4, s41, v3
  s_lshl_b32 s41, s14, 12
  s_lshl_b32 s42, s15, 9
  s_add_u32 s41, s41, s42
  s_add_u32 s41, s41, 135168
  v_add_u32 v6, s41, v5
  s_cmp_ge_i32 s60, 28
  s_cbranch_scc1 WLX_28
WL_27:
  ds_read_b32 v21, v19
  s_waitcnt lgkmcnt(0)
  v_readfirstlane_b32 s60, v21
  s_nop 0
  s_cmp_ge_i32 s60, 28
  s_cbranch_scc1 WLX_28
  s_cmp_eq_u32 s40, 0
  s_cbranch_scc1 WLX_28
  s_sub_u32 s40, s40, 1
  s_branch WL_27
WLX_28:
  ds_read_b64_tr_b16 v[24:25], v20 offset:14336
  ds_read_b64 v[26:27], v4 offset:0
  ds_read_b64_tr_b16 v[28:29], v20 offset:16384
  ds_read_b64 v[30:31], v4 offset:32
  ds_read_b64_tr_b16 v[32:33], v20 offset:18432
  ds_read_b64 v[34:35], v4 offset:64
  ds_read_b64_tr_b16 v[36:37], v20 offset:20480
  ds_read_b64 v[38:39], v4 offset:96
  ds_read_b64_tr_b16 v[40:41], v20 offset:22528
  ds_read_b64 v[42:43], v4 offset:128
  ds_read_b64_tr_b16 v[44:45], v20 offset:24576
  ds_read_b64 v[46:47], v4 offset:160
  ds_read_b64_tr_b16 v[48:49], v20 offset:26624
  ds_read_b64 v[50:51], v4 offset:192
  s_waitcnt lgkmcnt(12)
  v_mfma_f32_16x16x16_bf16 v[96:99], v[24:25], v[26:27], 0
  s_waitcnt lgkmcnt(10)
  v_mfma_f32_16x16x16_bf16 v[96:99], v[28:29], v[30:31], v[96:99]
  s_waitcnt lgkmcnt(8)
  v_mfma_f32_16x16x16_bf16 v[96:99], v[32:33], v[34:35], v[96:99]
  s_waitcnt lgkmcnt(6)
  v_mfma_f32_16x16x16_bf16 v[96:99], v[36:37], v[38:39], v[96:99]
  s_waitcnt lgkmcnt(4)
  v_mfma_f32_16x16x16_bf16 v[96:99], v[40:41], v[42:43], v[96:99]
  s_waitcnt lgkmcnt(2)
  v_mfma_f32_16x16x16_bf16 v[96:99], v[44:45], v[46:47], v[96:99]
  s_waitcnt lgkmcnt(0)
  v_mfma_f32_16x16x16_bf16 v[96:99], v[48:49], v[50:51], v[96:99]
  s_nop 7
  v_bfi_b32 v96, s39, v12, v96
  v_bfi_b32 v97, s39, v13, v97
  v_bfi_b32 v98, s39, v14, v98
  v_bfi_b32 v99, s39, v15, v99
  s_mov_b64 exec, s[54:55]
  global_store_dwordx4 v6, v[96:99], s[24:25] sc1
  s_mov_b64 exec, -1
NOGU_26:
  v_mov_b32 v100, v4
  v_add_u32 v101, 512, v6
  v_and_b32 v8, 7, v1
  v_lshlrev_b32 v8, 1, v8
  s_lshl_b32 s41, s31, 13
  v_lshlrev_b32 v9, 9, v1
  v_add_u32 v9, s41, v9
  v_add_u32 v4, 0, v2
  v_xor_b32 v4, v4, v8
  v_lshl_add_u32 v4, v4, 4, v9
  v_add_u32 v5, 4, v2
  v_xor_b32 v5, v5, v8
  v_lshl_add_u32 v5, v5, 4, v9
  v_add_u32 v6, 8, v2
  v_xor_b32 v6, v6, v8
  v_lshl_add_u32 v6, v6, 4, v9
  v_add_u32 v7, 12, v2
  v_xor_b32 v7, v7, v8
  v_lshl_add_u32 v7, v7, 4, v9
  s_lshl_b32 s41, s26, 14
  s_lshl_b32 s42, s31, 10
  s_add_u32 s41, s41, s42
  s_lshl_b32 s42, s28, 8
  s_add_u32 s41, s41, s42
  s_add_u32 s41, s41, 4096
  v_lshlrev_b32 v10, 12, v2
  v_lshl_add_u32 v10, v1, 4, v10
  v_add_u32 v10, s41, v10
  s_min_u32 s41, s3, 27
  s_lshl_b32 s41, s41, 12
  s_and_b32 s42, s31, 1
  s_lshl_b32 s42, s42, 8
  s_add_u32 s41, s41, s42
  s_add_u32 s41, s41, 135168
  v_lshlrev_b32 v11, 10, v2
  v_lshl_add_u32 v11, v1, 4, v11
  v_add_u32 v11, s41, v11
  s_lshl_b32 s41, s26, 9
  s_add_u32 s41, s41, 258048
  v_and_b32 v22, 31, v0
  v_lshlrev_b32 v22, 4, v22
  v_add_u32 v22, s41, v22
  s_lshl_b32 s41, s31, 3
  s_add_u32 s41, s41, s37
  s_add_u32 s41, s41, 8
  s_cmp_ge_i32 s60, s41
  s_cbranch_scc1 WLX_30
WL_29:
  ds_read_b32 v21, v19
  s_waitcnt lgkmcnt(0)
  v_readfirstlane_b32 s60, v21
  s_nop 0
  s_cmp_ge_i32 s60, s41
  s_cbranch_scc1 WLX_30
  s_cmp_eq_u32 s40, 0
  s_cbranch_scc1 WLX_30
  s_sub_u32 s40, s40, 1
  s_branch WL_29
WLX_30:
  ds_read_b128 v[128:131], v4 offset:0
  ds_read_b128 v[132:135], v5 offset:0
  ds_read_b128 v[136:139], v6 offset:0
  ds_read_b128 v[140:143], v7 offset:0
  ds_read_b128 v[144:147], v4 offset:256
  ds_read_b128 v[148:151], v5 offset:256
  ds_read_b128 v[152:155], v6 offset:256
  ds_read_b128 v[156:159], v7 offset:256
  s_waitcnt lgkmcnt(0)
  v_mov_b32 v21, 2
  ds_write_b32 v17, v21
  s_lshl_b32 s41, s31, 3
  s_add_u32 s41, s41, s37
  s_add_u32 s41, s41, 40
  s_cmp_ge_i32 s60, s41
  s_cbranch_scc1 WLX_32
WL_31:
  ds_read_b32 v21, v19
  s_waitcnt lgkmcnt(0)
  v_readfirstlane_b32 s60, v21
  s_nop 0
  s_cmp_ge_i32 s60, s41
  s_cbranch_scc1 WLX_32
  s_cmp_eq_u32 s40, 0
  s_cbranch_scc1 WLX_32
  s_sub_u32 s40, s40, 1
  s_branch WL_31
WLX_32:
  ds_read_b128 v[160:163], v4 offset:32768
  ds_read_b128 v[164:167], v5 offset:32768
  ds_read_b128 v[168:171], v6 offset:32768
  ds_read_b128 v[172:175], v7 offset:32768
  ds_read_b128 v[176:179], v4 offset:33024
  ds_read_b128 v[180:183], v5 offset:33024
  ds_read_b128 v[184:187], v6 offset:33024
  ds_read_b128 v[188:191], v7 offset:33024
  v_add_u32 v4, 0x10000, v4
  v_add_u32 v5, 0x10000, v5
  v_add_u32 v6, 0x10000, v6
  v_add_u32 v7, 0x10000, v7
  s_waitcnt lgkmcnt(0)
  v_mov_b32 v21, 3
  ds_write_b32 v17, v21
  s_cmp_eq_u32 s58, 0
  s_cbranch_scc1 NOG2_33
  s_add_u32 s41, s37, s58
  s_add_u32 s41, s41, 64
  s_cmp_ge_i32 s60, s41
  s_cbranch_scc1 WLX_35
WL_34:
  ds_read_b32 v21, v19
  s_waitcnt lgkmcnt(0)
  v_readfirstlane_b32 s60, v21
  s_nop 0
  s_cmp_ge_i32 s60, s41
  s_cbranch_scc1 WLX_35
  s_cmp_eq_u32 s40, 0
  s_cbranch_scc1 WLX_35
  s_sub_u32 s40, s40, 1
  s_branch WL_34
WLX_35:
  ds_read_b64_tr_b16 v[64:65], v20 offset:0
  ds_read_b64 v[66:67], v100 offset:0
  ds_read_b64_tr_b16 v[68:69], v20 offset:2048
  ds_read_b64 v[70:71], v100 offset:32
  ds_read_b64_tr_b16 v[72:73], v20 offset:4096
  ds_read_b64 v[74:75], v100 offset:64
  ds_read_b64_tr_b16 v[76:77], v20 offset:6144
  ds_read_b64 v[78:79], v100 offset:96
  ds_read_b64_tr_b16 v[80:81], v20 offset:8192
  ds_read_b64 v[82:83], v100 offset:128
  ds_read_b64_tr_b16 v[84:85], v20 offset:10240
  ds_read_b64 v[86:87], v100 offset:160
  ds_read_b64_tr_b16 v[88:89], v20 offset:12288
  ds_read_b64 v[90:91], v100 offset:192
  s_waitcnt lgkmcnt(12)
  v_mfma_f32_16x16x16_bf16 v[96:99], v[64:65], v[66:67], 0
  s_waitcnt lgkmcnt(10)
  v_mfma_f32_16x16x16_bf16 v[96:99], v[68:69], v[70:71], v[96:99]
  s_waitcnt lgkmcnt(8)
  v_mfma_f32_16x16x16_bf16 v[96:99], v[72:73], v[74:75], v[96:99]
  s_waitcnt lgkmcnt(6)
  v_mfma_f32_16x16x16_bf16 v[96:99], v[76:77], v[78:79], v[96:99]
  s_waitcnt lgkmcnt(4)
  v_mfma_f32_16x16x16_bf16 v[96:99], v[80:81], v[82:83], v[96:99]
  s_waitcnt lgkmcnt(2)
  v_mfma_f32_16x16x16_bf16 v[96:99], v[84:85], v[86:87], v[96:99]
  s_waitcnt lgkmcnt(0)
  v_mfma_f32_16x16x16_bf16 v[96:99], v[88:89], v[90:91], v[96:99]
  s_nop 7
  v_bfi_b32 v96, s39, v12, v96
  v_bfi_b32 v97, s39, v13, v97
  v_bfi_b32 v98, s39, v14, v98
  v_bfi_b32 v99, s39, v15, v99
  s_mov_b64 exec, s[54:55]
  global_store_dwordx4 v101, v[96:99], s[24:25] sc1
  s_mov_b64 exec, -1
NOG2_33:
  v_mov_b32 v21, 4
  ds_write_b32 v17, v21
  global_load_dwordx4 v[24:27], v10, s[24:25] sc1
  global_load_dwordx4 v[28:31], v10, s[24:25] offset:512 sc1
  global_load_dwordx4 v[56:59], v22, s[24:25] sc1
  s_lshl_b32 s41, s31, 3
  s_add_u32 s41, s41, s37
  s_add_u32 s41, s41, 72
  s_add_u32 s41, s41, s58
  s_cmp_ge_i32 s60, s41
  s_cbranch_scc1 WLX_37
WL_36:
  ds_read_b32 v21, v19
  s_waitcnt lgkmcnt(0)
  v_readfirstlane_b32 s60, v21
  s_nop 0
  s_cmp_ge_i32 s60, s41
  s_cbranch_scc1 WLX_37
  s_cmp_eq_u32 s40, 0
  s_cbranch_scc1 WLX_37
  s_sub_u32 s40, s40, 1
  s_branch WL_36
WLX_37:
  ds_read_b128 v[192:195], v4 offset:0
  ds_read_b128 v[196:199], v5 offset:0
  ds_read_b128 v[200:203], v6 offset:0
  ds_read_b128 v[204:207], v7 offset:0
  ds_read_b128 v[208:211], v4 offset:256
  ds_read_b128 v[212:215], v5 offset:256
  ds_read_b128 v[216:219], v6 offset:256
  ds_read_b128 v[220:223], v7 offset:256
  s_waitcnt lgkmcnt(0)
  v_mov_b32 v21, 5
  ds_write_b32 v17, v21
  s_lshl_b32 s41, s31, 3
  s_add_u32 s41, s41, s37
  s_add_u32 s41, s41, 104
  s_add_u32 s41, s41, s58
  s_cmp_ge_i32 s60, s41
  s_cbranch_scc1 WLX_39
WL_38:
  ds_read_b32 v21, v19
  s_waitcnt lgkmcnt(0)
  v_readfirstlane_b32 s60, v21
  s_nop 0
  s_cmp_ge_i32 s60, s41
  s_cbranch_scc1 WLX_39
  s_cmp_eq_u32 s40, 0
  s_cbranch_scc1 WLX_39
  s_sub_u32 s40, s40, 1
  s_branch WL_38
WLX_39:
  ds_read_b128 v[224:227], v4 offset:32768
  ds_read_b128 v[228:231], v5 offset:32768
  ds_read_b128 v[232:235], v6 offset:32768
  ds_read_b128 v[236:239], v7 offset:32768
  ds_read_b128 v[240:243], v4 offset:33024
  ds_read_b128 v[244:247], v5 offset:33024
  ds_read_b128 v[248:251], v6 offset:33024
  ds_read_b128 v[252:255], v7 offset:33024
  s_waitcnt lgkmcnt(0)
  v_mov_b32 v21, 6
  ds_write_b32 v17, v21
  s_branch PC_42
PL_40:
  global_load_dwordx4 v[24:27], v10, s[24:25] sc1
  global_load_dwordx4 v[28:31], v10, s[24:25] offset:512 sc1
  global_load_dwordx4 v[56:59], v22, s[24:25] sc1
PC_42:
  s_waitcnt vmcnt(0)
  v_xor_b32 v32, v24, v12
  v_bitop3_b32 v32, v25, v13, v32 bitop3:0xBE
  v_bitop3_b32 v32, v26, v14, v32 bitop3:0xBE
  v_bitop3_b32 v32, v27, v15, v32 bitop3:0xBE
  v_bitop3_b32 v32, v28, v12, v32 bitop3:0xBE
  v_bitop3_b32 v32, v29, v13, v32 bitop3:0xBE
  v_bitop3_b32 v32, v30, v14, v32 bitop3:0xBE
  v_bitop3_b32 v32, v31, v15, v32 bitop3:0xBE
  v_bitop3_b32 v32, v56, v12, v32 bitop3:0xBE
  v_bitop3_b32 v32, v57, v13, v32 bitop3:0xBE
  v_bitop3_b32 v32, v58, v14, v32 bitop3:0xBE
  v_bitop3_b32 v32, v59, v15, v32 bitop3:0xBE
  v_and_b32 v32, s39, v32
  v_cmp_ne_u32 vcc, 0, v32
  s_cbranch_vccz PX_41
  s_cmp_eq_u32 s40, 0
  s_cbranch_scc1 PX_41
  s_sub_u32 s40, s40, 1
  s_sleep 8
  s_branch PL_40
PX_41:
  s_cmp_eq_u32 s35, 0
  s_cbranch_scc1 NOGL_43
  s_cmp_ge_u32 s31, 2
  s_cbranch_scc1 NOGL_43
  global_load_dwordx4 v[44:47], v11, s[24:25] sc1
  global_load_dwordx4 v[48:51], v11, s[24:25] offset:512 sc1
NOGL_43:
  v_lshrrev_b32 v56, 16, v56
  v_cmp_eq_u32 vcc, s53, v56
  s_nop 0
  s_cmp_eq_u64 vcc, exec
  s_cselect_b32 s59, 1, 0
  v_bfi_b32 v24, s39, v16, v24
  v_bfi_b32 v25, s39, v16, v25
  v_bfi_b32 v26, s39, v16, v26
  v_bfi_b32 v27, s39, v16, v27
  v_bfi_b32 v28, s39, v16, v28
  v_bfi_b32 v29, s39, v16, v29
  v_bfi_b32 v30, s39, v16, v30
  v_bfi_b32 v31, s39, v16, v31
  v_permlane16_swap_b32 v24, v25
  v_permlane16_swap_b32 v26, v27
  v_add_f32 v24, v24, v25
  v_add_f32 v26, v26, v27
  s_nop 1
  v_permlane32_swap_b32 v24, v26
  v_add_f32 v24, v24, v26
  v_permlane16_swap_b32 v28, v29
  v_permlane16_swap_b32 v30, v31
  v_add_f32 v28, v28, v29
  v_add_f32 v30, v30, v31
  s_nop 1
  v_permlane32_swap_b32 v28, v30
  v_add_f32 v28, v28, v30
  v_cvt_pk_bf16_f32 v24, v24, v28
  s_lshr_b32 s41, s31, 1
  s_lshl_b32 s41, s41, 9
  s_and_b32 s42, s31, 1
  s_lshl_b32 s42, s42, 8
  s_add_u32 s41, s41, s42
  s_add_u32 s41, s41, 161536
  v_lshlrev_b32 v4, 3, v1
  v_lshl_add_u32 v4, v2, 1, v4
  v_add_u32 v4, s41, v4
  ds_write_b16 v4, v24
  ds_write_b16_d16_hi v4, v24 offset:128
  v_mov_b32 v21, 7
  ds_write_b32 v17, v21
WP_44:
  ds_read_b128 v[60:63], v18
  s_waitcnt lgkmcnt(0)
  v_min3_i32 v60, v60, v61, v62
  v_min_i32 v60, v60, v63
  v_cmp_gt_i32 vcc, 7, v60
  s_cbranch_vccz WPX_45
  s_cmp_eq_u32 s40, 0
  s_cbranch_scc1 WPX_45
  s_sub_u32 s40, s40, 1
  s_branch WP_44
WPX_45:
  v_and_b32 v4, 1, v1
  v_lshlrev_b32 v4, 9, v4
  v_lshl_add_u32 v4, v2, 4, v4
  v_add_u32 v4, 161536, v4
  ds_read_b128 v[64:67], v4 offset:0
  ds_read_b128 v[68:71], v4 offset:64
  ds_read_b128 v[72:75], v4 offset:128
  ds_read_b128 v[76:79], v4 offset:192
  ds_read_b128 v[80:83], v4 offset:256
  ds_read_b128 v[84:87], v4 offset:320
  ds_read_b128 v[88:91], v4 offset:384
  ds_read_b128 v[92:95], v4 offset:448
  s_waitcnt lgkmcnt(7)
  v_mfma_f32_16x16x32_bf16 v[96:99], v[128:131], v[64:67], 0
  v_mfma_f32_16x16x32_bf16 v[100:103], v[160:163], v[64:67], 0
  v_mfma_f32_16x16x32_bf16 v[104:107], v[192:195], v[64:67], 0
  v_mfma_f32_16x16x32_bf16 v[108:111], v[224:227], v[64:67], 0
  s_waitcnt lgkmcnt(6)
  v_mfma_f32_16x16x32_bf16 v[96:99], v[132:135], v[68:71], v[96:99]
  v_mfma_f32_16x16x32_bf16 v[100:103], v[164:167], v[68:71], v[100:103]
  v_mfma_f32_16x16x32_bf16 v[104:107], v[196:199], v[68:71], v[104:107]
  v_mfma_f32_16x16x32_bf16 v[108:111], v[228:231], v[68:71], v[108:111]
  s_waitcnt lgkmcnt(5)
  v_mfma_f32_16x16x32_bf16 v[96:99], v[136:139], v[72:75], v[96:99]
  v_mfma_f32_16x16x32_bf16 v[100:103], v[168:171], v[72:75], v[100:103]
  v_mfma_f32_16x16x32_bf16 v[104:107], v[200:203], v[72:75], v[104:107]
  v_mfma_f32_16x16x32_bf16 v[108:111], v[232:235], v[72:75], v[108:111]
  s_waitcnt lgkmcnt(4)
  v_mfma_f32_16x16x32_bf16 v[96:99], v[140:143], v[76:79], v[96:99]
  v_mfma_f32_16x16x32_bf16 v[100:103], v[172:175], v[76:79], v[100:103]
  v_mfma_f32_16x16x32_bf16 v[104:107], v[204:207], v[76:79], v[104:107]
  v_mfma_f32_16x16x32_bf16 v[108:111], v[236:239], v[76:79], v[108:111]
  s_waitcnt lgkmcnt(3)
  v_mfma_f32_16x16x32_bf16 v[96:99], v[144:147], v[80:83], v[96:99]
  v_mfma_f32_16x16x32_bf16 v[100:103], v[176:179], v[80:83], v[100:103]
  v_mfma_f32_16x16x32_bf16 v[104:107], v[208:211], v[80:83], v[104:107]
  v_mfma_f32_16x16x32_bf16 v[108:111], v[240:243], v[80:83], v[108:111]
  s_waitcnt lgkmcnt(2)
  v_mfma_f32_16x16x32_bf16 v[96:99], v[148:151], v[84:87], v[96:99]
  v_mfma_f32_16x16x32_bf16 v[100:103], v[180:183], v[84:87], v[100:103]
  v_mfma_f32_16x16x32_bf16 v[104:107], v[212:215], v[84:87], v[104:107]
  v_mfma_f32_16x16x32_bf16 v[108:111], v[244:247], v[84:87], v[108:111]
  s_waitcnt lgkmcnt(1)
  v_mfma_f32_16x16x32_bf16 v[96:99], v[152:155], v[88:91], v[96:99]
  v_mfma_f32_16x16x32_bf16 v[100:103], v[184:187], v[88:91], v[100:103]
  v_mfma_f32_16x16x32_bf16 v[104:107], v[216:219], v[88:91], v[104:107]
  v_mfma_f32_16x16x32_bf16 v[108:111], v[248:251], v[88:91], v[108:111]
  s_waitcnt lgkmcnt(0)
  v_mfma_f32_16x16x32_bf16 v[96:99], v[156:159], v[92:95], v[96:99]
  v_mfma_f32_16x16x32_bf16 v[100:103], v[188:191], v[92:95], v[100:103]
  v_mfma_f32_16x16x32_bf16 v[104:107], v[220:223], v[92:95], v[104:107]
  v_mfma_f32_16x16x32_bf16 v[108:111], v[252:255], v[92:95], v[108:111]
  s_nop 4
  v_cvt_pk_bf16_f32 v4, v96, v97
  v_lshlrev_b32 v96, 16, v4
  v_and_b32 v97, s57, v4
  v_cvt_pk_bf16_f32 v4, v98, v99
  v_lshlrev_b32 v98, 16, v4
  v_and_b32 v99, s57, v4
  v_cvt_pk_bf16_f32 v4, v100, v101
  v_lshlrev_b32 v100, 16, v4
  v_and_b32 v101, s57, v4
  v_cvt_pk_bf16_f32 v4, v102, v103
  v_lshlrev_b32 v102, 16, v4
  v_and_b32 v103, s57, v4
  v_cvt_pk_bf16_f32 v4, v104, v105
  v_lshlrev_b32 v104, 16, v4
  v_and_b32 v105, s57, v4
  v_cvt_pk_bf16_f32 v4, v106, v107
  v_lshlrev_b32 v106, 16, v4
  v_and_b32 v107, s57, v4
  v_cvt_pk_bf16_f32 v4, v108, v109
  v_lshlrev_b32 v108, 16, v4
  v_and_b32 v109, s57, v4
  v_cvt_pk_bf16_f32 v4, v110, v111
  v_lshlrev_b32 v110, 16, v4
  v_and_b32 v111, s57, v4
  v_max3_f32 v4, v96, v97, v98
  v_max3_f32 v4, v4, v99, v100
  v_max3_f32 v4, v4, v101, v102
  v_max3_f32 v4, v4, v103, v104
  v_max3_f32 v4, v4, v105, v106
  v_max3_f32 v4, v4, v107, v108
  v_max3_f32 v4, v4, v109, v110
  v_max_f32 v4, v4, v111
  v_mov_b32 v5, v4
  s_nop 1
  v_permlane16_swap_b32 v4, v5
  v_max_f32 v4, v4, v5
  v_mov_b32 v5, v4
  s_nop 1
  v_permlane32_swap_b32 v4, v5
  v_max_f32 v4, v4, v5
  v_and_b32 v6, 1, v1
  v_lshlrev_b32 v6, 4, v6
  v_add_u32 v6, 162816, v6
  s_lshl_b32 s41, s31, 2
  v_add_u32 v7, s41, v6
  ds_write_b32 v7, v4
  v_mov_b32 v21, 8
  ds_write_b32 v17, v21
WP_46:
  ds_read_b128 v[60:63], v18
  s_waitcnt lgkmcnt(0)
  v_min3_i32 v60, v60, v61, v62
  v_min_i32 v60, v60, v63
  v_cmp_gt_i32 vcc, 8, v60
  s_cbranch_vccz WPX_47
  s_cmp_eq_u32 s40, 0
  s_cbranch_scc1 WPX_47
  s_sub_u32 s40, s40, 1
  s_branch WP_46
WPX_47:
  ds_read_b128 v[24:27], v6
  s_waitcnt lgkmcnt(0)
  v_max3_f32 v4, v24, v25, v26
  v_max_f32 v4, v4, v27
  v_mul_f32 v5, s56, v4
  v_fma_f32 v96, v96, s56, -v5
  v_fma_f32 v97, v97, s56, -v5
  v_fma_f32 v98, v98, s56, -v5
  v_fma_f32 v99, v99, s56, -v5
  v_fma_f32 v100, v100, s56, -v5
  v_fma_f32 v101, v101, s56, -v5
  v_fma_f32 v102, v102, s56, -v5
  v_fma_f32 v103, v103, s56, -v5
  v_fma_f32 v104, v104, s56, -v5
  v_fma_f32 v105, v105, s56, -v5
  v_fma_f32 v106, v106, s56, -v5
  v_fma_f32 v107, v107, s56, -v5
  v_fma_f32 v108, v108, s56, -v5
  v_fma_f32 v109, v109, s56, -v5
  v_fma_f32 v110, v110, s56, -v5
  v_fma_f32 v111, v111, s56, -v5
  v_exp_f32 v96, v96
  v_exp_f32 v97, v97
  v_exp_f32 v98, v98
  v_exp_f32 v99, v99
  v_exp_f32 v100, v100
  v_exp_f32 v101, v101
  v_exp_f32 v102, v102
  v_exp_f32 v103, v103
  v_exp_f32 v104, v104
  v_exp_f32 v105, v105
  v_exp_f32 v106, v106
  v_exp_f32 v107, v107
  v_exp_f32 v108, v108
  v_exp_f32 v109, v109
  v_exp_f32 v110, v110
  v_exp_f32 v111, v111
  v_add_f32 v8, v96, v97
  v_add_f32 v8, v8, v98
  v_add_f32 v8, v8, v99
  v_add_f32 v8, v8, v100
  v_add_f32 v8, v8, v101
  v_add_f32 v8, v8, v102
  v_add_f32 v8, v8, v103
  v_add_f32 v8, v8, v104
  v_add_f32 v8, v8, v105
  v_add_f32 v8, v8, v106
  v_add_f32 v8, v8, v107
  v_add_f32 v8, v8, v108
  v_add_f32 v8, v8, v109
  v_add_f32 v8, v8, v110
  v_add_f32 v8, v8, v111
  v_mov_b32 v9, v8
  s_nop 1
  v_permlane16_swap_b32 v8, v9
  v_add_f32 v8, v8, v9
  v_mov_b32 v9, v8
  s_nop 1
  v_permlane32_swap_b32 v8, v9
  v_add_f32 v8, v8, v9
  ds_write_b32 v7, v8 offset:32
  v_and_b32 v9, 1, v1
  v_lshlrev_b32 v9, 5, v9
  v_lshl_add_u32 v9, v2, 3, v9
  v_add_u32 v3, 159744, v9
  s_lshl_b32 s41, s31, 6
  v_add_u32 v10, s41, v3
  v_cvt_pk_bf16_f32 v24, v96, v97
  v_cvt_pk_bf16_f32 v25, v98, v99
  ds_write_b64 v10, v[24:25] offset:0
  v_cvt_pk_bf16_f32 v26, v100, v101
  v_cvt_pk_bf16_f32 v27, v102, v103
  ds_write_b64 v10, v[26:27] offset:256
  v_cvt_pk_bf16_f32 v28, v104, v105
  v_cvt_pk_bf16_f32 v29, v106, v107
  ds_write_b64 v10, v[28:29] offset:512
  v_cvt_pk_bf16_f32 v30, v108, v109
  v_cvt_pk_bf16_f32 v31, v110, v111
  ds_write_b64 v10, v[30:31] offset:768
  v_mov_b32 v21, 9
  ds_write_b32 v17, v21
WP_48:
  ds_read_b128 v[60:63], v18
  s_waitcnt lgkmcnt(0)
  v_min3_i32 v60, v60, v61, v62
  v_min_i32 v60, v60, v63
  v_cmp_gt_i32 vcc, 9, v60
  s_cbranch_vccz WPX_49
  s_cmp_eq_u32 s40, 0
  s_cbranch_scc1 WPX_49
  s_sub_u32 s40, s40, 1
  s_branch WP_48
WPX_49:
  s_cmp_lg_u32 s31, 0
  s_cbranch_scc1 NOST_50
  ds_read_b128 v[24:27], v6 offset:32
  s_waitcnt lgkmcnt(0)
  v_add_f32 v24, v24, v25
  v_add_f32 v26, v26, v27
  v_add_f32 v25, v24, v26
  v_mov_b32 v24, v4
  v_mov_b32 v26, v4
  v_mov_b32 v27, v25
  v_bfi_b32 v24, s39, v12, v24
  v_bfi_b32 v25, s39, v13, v25
  v_bfi_b32 v26, s39, v14, v26
  v_bfi_b32 v27, s39, v15, v27
  s_lshl_b32 s41, s26, 1
  s_add_u32 s41, s41, s28
  s_lshl_b32 s41, s41, 4
  s_add_u32 s41, s41, s29
  s_lshl_b32 s41, s41, 5
  s_add_u32 s41, s41, 249856
  v_lshlrev_b32 v5, 4, v0
  v_add_u32 v5, s41, v5
  s_mov_b64 exec, 3
  global_store_dwordx4 v5, v[24:27], s[24:25] sc1
  s_mov_b64 exec, -1
NOST_50:
  s_cmp_eq_u32 s35, 0
  s_cbranch_scc1 NOFFN_51
  s_cmp_ge_u32 s31, 2
  s_cbranch_scc1 NOH_52
  s_branch PC_55
PL_53:
  global_load_dwordx4 v[44:47], v11, s[24:25] sc1
  global_load_dwordx4 v[48:51], v11, s[24:25] offset:512 sc1
PC_55:
  s_waitcnt vmcnt(0)
  v_xor_b32 v32, v44, v12
  v_bitop3_b32 v32, v45, v13, v32 bitop3:0xBE
  v_bitop3_b32 v32, v46, v14, v32 bitop3:0xBE
  v_bitop3_b32 v32, v47, v15, v32 bitop3:0xBE
  v_bitop3_b32 v32, v48, v12, v32 bitop3:0xBE
  v_bitop3_b32 v32, v49, v13, v32 bitop3:0xBE
  v_bitop3_b32 v32, v50, v14, v32 bitop3:0xBE
  v_bitop3_b32 v32, v51, v15, v32 bitop3:0xBE
  v_and_b32 v32, s39, v32
  v_cmp_ne_u32 vcc, 0, v32
  s_cbranch_vccz PX_54
  s_cmp_eq_u32 s40, 0
  s_cbranch_scc1 PX_54
  s_sub_u32 s40, s40, 1
  s_sleep 8
  s_branch PL_53
PX_54:
  v_bfi_b32 v44, s39, v16, v44
  v_bfi_b32 v45, s39, v16, v45
  v_bfi_b32 v46, s39, v16, v46
  v_bfi_b32 v47, s39, v16, v47
  v_bfi_b32 v48, s39, v16, v48
  v_bfi_b32 v49, s39, v16, v49
  v_bfi_b32 v50, s39, v16, v50
  v_bfi_b32 v51, s39, v16, v51
  v_permlane16_swap_b32 v44, v45
  v_permlane16_swap_b32 v46, v47
  v_add_f32 v44, v44, v45
  v_add_f32 v46, v46, v47
  s_nop 1
  v_permlane32_swap_b32 v44, v46
  v_add_f32 v44, v44, v46
  v_permlane16_swap_b32 v48, v49
  v_permlane16_swap_b32 v50, v51
  v_add_f32 v48, v48, v49
  v_add_f32 v50, v50, v51
  s_nop 1
  v_permlane32_swap_b32 v48, v50
  v_add_f32 v48, v48, v50
  v_cvt_pk_bf16_f32 v24, v44, v44
  v_and_b32 v24, s57, v24
  v_cvt_pk_bf16_f32 v28, v48, v48
  v_and_b32 v28, s57, v28
  v_mul_f32 v5, v24, v24
  v_mov_b32 v6, 0x3d372713
  v_fma_f32 v5, v5, v6, 1.0
  v_mul_f32 v5, v5, v24
  v_mul_f32 v5, 0xc0135761, v5
  v_exp_f32 v5, v5
  s_nop 0
  v_add_f32 v5, 1.0, v5
  v_rcp_f32 v5, v5
  s_nop 0
  v_mul_f32 v5, v5, v24
  v_cvt_pk_bf16_f32 v5, v5, v5
  v_and_b32 v5, s57, v5
  v_mul_f32 v5, v5, v28
  v_cvt_pk_bf16_f32 v5, v5, v5
  s_lshl_b32 s41, s31, 7
  s_add_u32 s41, s41, 162560
  v_lshlrev_b32 v4, 3, v1
  v_lshl_add_u32 v4, v2, 1, v4
  v_add_u32 v4, s41, v4
  ds_write_b16 v4, v5
NOH_52:
  v_mov_b32 v21, 10
  ds_write_b32 v17, v21
  s_lshl_b32 s41, s96, 14
  s_lshr_b32 s42, s31, 1
  s_lshl_b32 s42, s42, 12
  s_add_u32 s41, s41, s42
  s_lshl_b32 s42, s3, 7
  s_add_u32 s41, s41, s42
  s_and_b32 s42, s31, 1
  s_lshl_b32 s42, s42, 6
  s_add_u32 s41, s41, s42
  s_add_u32 s41, s41, 262144
  v_lshlrev_b32 v6, 13, v1
  v_lshl_add_u32 v6, v2, 4, v6
  v_add_u32 v6, s41, v6
  v_and_b32 v4, 1, v1
  v_lshlrev_b32 v4, 7, v4
  v_lshl_add_u32 v4, v2, 3, v4
  v_add_u32 v4, 162560, v4
WP_56:
  ds_read_b128 v[60:63], v18
  s_waitcnt lgkmcnt(0)
  v_min3_i32 v60, v60, v61, v62
  v_min_i32 v60, v60, v63
  v_cmp_gt_i32 vcc, 10, v60
  s_cbranch_vccz WPX_57
  s_cmp_eq_u32 s40, 0
  s_cbranch_scc1 WPX_57
  s_sub_u32 s40, s40, 1
  s_branch WP_56
WPX_57:
  s_cmp_ge_i32 s60, s38
  s_cbranch_scc1 WLX_59
WL_58:
  ds_read_b32 v21, v19
  s_waitcnt lgkmcnt(0)
  v_readfirstlane_b32 s60, v21
  s_nop 0
  s_cmp_ge_i32 s60, s38
  s_cbranch_scc1 WLX_59
  s_cmp_eq_u32 s40, 0
  s_cbranch_scc1 WLX_59
  s_sub_u32 s40, s40, 1
  s_branch WL_58
WLX_59:
  ds_read_b64_tr_b16 v[24:25], v20 offset:0
  ds_read_b64 v[26:27], v4 offset:0
  ds_read_b64_tr_b16 v[28:29], v20 offset:2048
  ds_read_b64 v[30:31], v4 offset:32
  ds_read_b64_tr_b16 v[32:33], v20 offset:4096
  ds_read_b64 v[34:35], v4 offset:64
  ds_read_b64_tr_b16 v[36:37], v20 offset:6144
  ds_read_b64 v[38:39], v4 offset:96
  s_waitcnt lgkmcnt(6)
  v_mfma_f32_16x16x16_bf16 v[40:43], v[24:25], v[26:27], 0
  s_waitcnt lgkmcnt(4)
  v_mfma_f32_16x16x16_bf16 v[40:43], v[28:29], v[30:31], v[40:43]
  s_waitcnt lgkmcnt(2)
  v_mfma_f32_16x16x16_bf16 v[40:43], v[32:33], v[34:35], v[40:43]
  s_waitcnt lgkmcnt(0)
  v_mfma_f32_16x16x16_bf16 v[40:43], v[36:37], v[38:39], v[40:43]
  s_nop 7
  v_bfi_b32 v40, s39, v12, v40
  v_bfi_b32 v41, s39, v13, v41
  v_bfi_b32 v42, s39, v14, v42
  v_bfi_b32 v43, s39, v15, v43
  s_mov_b64 exec, s[54:55]
  global_store_dwordx4 v6, v[40:43], s[24:25] sc1
  s_mov_b64 exec, -1
NOFFN_51:
  s_lshl_b32 s41, s26, 1
  s_add_u32 s41, s41, s28
  s_lshl_b32 s41, s41, 4
  s_add_u32 s41, s41, s29
  s_lshl_b32 s41, s41, 11
  s_lshl_b32 s42, s31, 8
  s_add_u32 s41, s41, s42
  s_add_u32 s41, s41, 524288
  v_lshlrev_b32 v128, 10, v1
  v_lshl_add_u32 v128, v2, 4, v128
  v_add_u32 v128, s41, v128
  v_bfe_u32 v23, v0, 4, 1
  v_lshlrev_b32 v23, 10, v23
  v_lshl_add_u32 v23, v1, 4, v23
  v_add_u32 v23, s41, v23
  s_lshl_b32 s41, s26, 1
  s_lshr_b32 s42, s31, 1
  s_add_u32 s41, s41, s42
  s_lshl_b32 s41, s41, 15
  s_and_b32 s42, s50, 3
  s_lshl_b32 s42, s42, 9
  s_add_u32 s41, s41, s42
  s_and_b32 s42, s31, 1
  s_lshl_b32 s42, s42, 8
  s_add_u32 s41, s41, s42
  s_add_u32 s41, s41, 524288
  v_lshlrev_b32 v129, 11, v2
  v_lshl_add_u32 v129, v1, 4, v129
  v_add_u32 v129, s41, v129
  v_add_u32 v130, 8192, v129
  v_add_u32 v131, 16384, v129
  v_add_u32 v132, 24576, v129
  v_lshrrev_b32 v8, 3, v1
  v_lshlrev_b32 v8, 5, v8
  v_and_b32 v9, 3, v1
  v_lshl_add_u32 v8, v9, 3, v8
  v_bfe_u32 v9, v1, 2, 1
  v_lshl_add_u32 v8, v9, 2, v8
  v_add_u32 v8, v8, v2
  v_lshlrev_b32 v8, 1, v8
  s_lshr_b32 s41, s31, 1
  s_lshl_b32 s41, s41, 8
  s_and_b32 s42, s31, 1
  s_lshl_b32 s42, s42, 7
  s_add_u32 s41, s41, s42
  s_add_u32 s41, s41, 161536
  v_add_u32 v133, s41, v8
  v_and_b32 v9, 1, v1
  v_lshlrev_b32 v9, 8, v9
  v_lshl_add_u32 v9, v2, 4, v9
  v_add_u32 v134, 161536, v9
  s_lshl_b32 s45, s26, 2
  s_add_u32 s45, s45, s50
  s_and_b32 s45, s45, 31
  s_min_u32 s46, s51, 6
  s_lshl_b32 s41, s46, 14
  s_lshr_b32 s42, s31, 1
  s_lshl_b32 s42, s42, 12
  s_add_u32 s41, s41, s42
  s_lshl_b32 s42, s45, 7
  s_add_u32 s41, s41, s42
  s_and_b32 s42, s31, 1
  s_lshl_b32 s42, s42, 6
  s_add_u32 s41, s41, s42
  s_add_u32 s41, s41, 393216
  v_lshlrev_b32 v135, 13, v1
  v_lshl_add_u32 v135, v2, 4, v135
  v_add_u32 v135, s41, v135
  s_lshl_b32 s41, s26, 10
  s_lshr_b32 s42, s50, 1
  s_and_b32 s42, s42, 1
  s_lshl_b32 s42, s42, 4
  s_add_u32 s41, s41, s42
  s_add_u32 s41, s41, 249856
  v_and_b32 v136, 31, v0
  v_lshlrev_b32 v136, 5, v136
  v_add_u32 v136, s41, v136
  s_min_u32 s47, s52, 27
  s_cmp_ge_u32 s47, 14
  s_cselect_b32 s42, 1, 0
  s_mul_i32 s43, s42, 14
  s_sub_u32 s43, s47, s43
  s_lshr_b32 s44, s43, 1
  s_and_b32 s43, s43, 1
  s_lshl_b32 s41, s44, 1
  s_add_u32 s41, s41, s42
  s_lshl_b32 s41, s41, 1
  s_add_u32 s41, s41, s43
  s_lshl_b32 s41, s41, 12
  v_lshlrev_b32 v138, 4, v0
  v_add_u32 v138, s41, v138
  s_mul_i32 s42, s42, 448
  s_lshl_b32 s44, s44, 6
  s_add_u32 s42, s42, s44
  s_lshl_b32 s43, s43, 5
  s_add_u32 s42, s42, s43
  v_and_b32 v137, 7, v0
  v_lshl_add_u32 v137, v137, 2, v2
  v_add_u32 v137, s42, v137
  v_lshlrev_b32 v137, 1, v137
  v_lshrrev_b32 v8, 2, v1
  v_lshl_add_u32 v8, v2, 2, v8
  v_and_b32 v9, 7, v8
  v_lshlrev_b32 v8, 9, v8
  v_and_b32 v10, 3, v1
  v_lshl_add_u32 v8, v10, 3, v8
  s_lshl_b32 s41, s31, 2
  s_add_u32 s42, s41, 0
  v_xor_b32 v4, s42, v9
  v_lshl_add_u32 v4, v4, 5, v8
  s_add_u32 s42, s41, 1
  v_xor_b32 v5, s42, v9
  v_lshl_add_u32 v5, v5, 5, v8
  s_add_u32 s42, s41, 2
  v_xor_b32 v6, s42, v9
  v_lshl_add_u32 v6, v6, 5, v8
  s_add_u32 s42, s41, 3
  v_xor_b32 v7, s42, v9
  v_lshl_add_u32 v7, v7, 5, v8
  v_mov_b32 v112, 0
  v_mov_b32 v113, 0
  v_mov_b32 v114, 0
  v_mov_b32 v115, 0
  v_mov_b32 v116, 0
  v_mov_b32 v117, 0
  v_mov_b32 v118, 0
  v_mov_b32 v119, 0
  v_mov_b32 v120, 0
  v_mov_b32 v121, 0
  v_mov_b32 v122, 0
  v_mov_b32 v123, 0
  v_mov_b32 v124, 0
  v_mov_b32 v125, 0
  v_mov_b32 v126, 0
  v_mov_b32 v127, 0
  s_add_u32 s61, s38, 8
  s_mov_b32 s62, 12
PV_60:
  s_cmp_ge_i32 s60, s61
  s_cbranch_scc1 WLX_62
WL_61:
  ds_read_b32 v21, v19
  s_waitcnt lgkmcnt(0)
  v_readfirstlane_b32 s60, v21
  s_nop 0
  s_cmp_ge_i32 s60, s61
  s_cbranch_scc1 WLX_62
  s_cmp_eq_u32 s40, 0
  s_cbranch_scc1 WLX_62
  s_sub_u32 s40, s40, 1
  s_branch WL_61
WLX_62:
  ds_read_b64 v[24:25], v3
  ds_read_b64_tr_b16 v[26:27], v4
  ds_read_b64_tr_b16 v[28:29], v5
  ds_read_b64_tr_b16 v[30:31], v6
  ds_read_b64_tr_b16 v[32:33], v7
  v_add_u32 v4, 8192, v4
  v_add_u32 v5, 8192, v5
  v_add_u32 v6, 8192, v6
  v_add_u32 v7, 8192, v7
  v_add_u32 v3, 64, v3
  s_add_u32 s61, s61, 8
  s_sub_u32 s62, s62, 1
  s_waitcnt lgkmcnt(3)
  v_mfma_f32_16x16x16_bf16 v[112:115], v[26:27], v[24:25], v[112:115]
  s_waitcnt lgkmcnt(2)
  v_mfma_f32_16x16x16_bf16 v[116:119], v[28:29], v[24:25], v[116:119]
  s_waitcnt lgkmcnt(1)
  v_mfma_f32_16x16x16_bf16 v[120:123], v[30:31], v[24:25], v[120:123]
  s_waitcnt lgkmcnt(0)
  v_mfma_f32_16x16x16_bf16 v[124:127], v[32:33], v[24:25], v[124:127]
  s_cmp_lg_u32 s62, 0
  s_cbranch_scc1 PV_60
  s_cmp_eq_u32 s36, 0
  s_cbranch_scc1 PFIN_63
  global_load_dwordx4 v[40:43], v136, s[24:25] sc1
PFIN_63:
  global_load_dwordx4 v[44:47], v23, s[24:25] sc1
  s_mov_b32 s62, 3
PV_65:
  s_cmp_ge_i32 s60, s61
  s_cbranch_scc1 WLX_67
WL_66:
  ds_read_b32 v21, v19
  s_waitcnt lgkmcnt(0)
  v_readfirstlane_b32 s60, v21
  s_nop 0
  s_cmp_ge_i32 s60, s61
  s_cbranch_scc1 WLX_67
  s_cmp_eq_u32 s40, 0
  s_cbranch_scc1 WLX_67
  s_sub_u32 s40, s40, 1
  s_branch WL_66
WLX_67:
  ds_read_b64 v[24:25], v3
  ds_read_b64_tr_b16 v[26:27], v4
  ds_read_b64_tr_b16 v[28:29], v5
  ds_read_b64_tr_b16 v[30:31], v6
  ds_read_b64_tr_b16 v[32:33], v7
  v_add_u32 v4, 8192, v4
  v_add_u32 v5, 8192, v5
  v_add_u32 v6, 8192, v6
  v_add_u32 v7, 8192, v7
  v_add_u32 v3, 64, v3
  s_add_u32 s61, s61, 8
  s_sub_u32 s62, s62, 1
  s_waitcnt lgkmcnt(3)
  v_mfma_f32_16x16x16_bf16 v[112:115], v[26:27], v[24:25], v[112:115]
  s_waitcnt lgkmcnt(2)
  v_mfma_f32_16x16x16_bf16 v[116:119], v[28:29], v[24:25], v[116:119]
  s_waitcnt lgkmcnt(1)
  v_mfma_f32_16x16x16_bf16 v[120:123], v[30:31], v[24:25], v[120:123]
  s_waitcnt lgkmcnt(0)
  v_mfma_f32_16x16x16_bf16 v[124:127], v[32:33], v[24:25], v[124:127]
  s_cmp_lg_u32 s62, 0
  s_cbranch_scc1 PV_65
  ds_read_b64 v[24:25], v3
  s_waitcnt lgkmcnt(0)
  s_barrier
  ds_read_b64_tr_b16 v[26:27], v4
  ds_read_b64_tr_b16 v[28:29], v5
  ds_read_b64_tr_b16 v[30:31], v6
  ds_read_b64_tr_b16 v[32:33], v7
  s_waitcnt lgkmcnt(3)
  v_mfma_f32_16x16x16_bf16 v[112:115], v[26:27], v[24:25], v[112:115]
  s_waitcnt lgkmcnt(2)
  v_mfma_f32_16x16x16_bf16 v[116:119], v[28:29], v[24:25], v[116:119]
  s_waitcnt lgkmcnt(1)
  v_mfma_f32_16x16x16_bf16 v[120:123], v[30:31], v[24:25], v[120:123]
  s_waitcnt lgkmcnt(0)
  v_mfma_f32_16x16x16_bf16 v[124:127], v[32:33], v[24:25], v[124:127]
  s_nop 1
  v_bfi_b32 v112, s39, v12, v112
  v_bfi_b32 v113, s39, v13, v113
  v_bfi_b32 v114, s39, v14, v114
  v_bfi_b32 v115, s39, v15, v115
  v_bfi_b32 v116, s39, v12, v116
  v_bfi_b32 v117, s39, v13, v117
  v_bfi_b32 v118, s39, v14, v118
  v_bfi_b32 v119, s39, v15, v119
  v_bfi_b32 v120, s39, v12, v120
  v_bfi_b32 v121, s39, v13, v121
  v_bfi_b32 v122, s39, v14, v122
  v_bfi_b32 v123, s39, v15, v123
  v_bfi_b32 v124, s39, v12, v124
  v_bfi_b32 v125, s39, v13, v125
  v_bfi_b32 v126, s39, v14, v126
  v_bfi_b32 v127, s39, v15, v127
  s_mov_b64 exec, s[54:55]
  s_cmp_eq_u32 s59, 0
  s_cbranch_scc1 OSLOW_68
  global_store_dwordx4 v128, v[112:115], s[24:25] offset:0
  global_store_dwordx4 v128, v[116:119], s[24:25] offset:64
  global_store_dwordx4 v128, v[120:123], s[24:25] offset:128
  global_store_dwordx4 v128, v[124:127], s[24:25] offset:192
  s_branch ODONE_69
OSLOW_68:
  global_store_dwordx4 v128, v[112:115], s[24:25] offset:0 sc1
  global_store_dwordx4 v128, v[116:119], s[24:25] offset:64 sc1
  global_store_dwordx4 v128, v[120:123], s[24:25] offset:128 sc1
  global_store_dwordx4 v128, v[124:127], s[24:25] offset:192 sc1
ODONE_69:
  s_mov_b64 exec, -1
  s_cmp_eq_u32 s36, 0
  s_cbranch_scc1 FIN2_70
  s_waitcnt vmcnt(4)
SL_72:
  v_xor_b32 v57, v40, v12
  v_bitop3_b32 v57, v41, v13, v57 bitop3:0xBE
  v_bitop3_b32 v57, v42, v14, v57 bitop3:0xBE
  v_bitop3_b32 v57, v43, v15, v57 bitop3:0xBE
  v_and_b32 v57, s39, v57
  v_cmp_ne_u32 vcc, 0, v57
  s_cbranch_vccz SX_73
  s_cmp_eq_u32 s40, 0
  s_cbranch_scc1 SX_73
  s_sub_u32 s40, s40, 1
  global_load_dwordx4 v[40:43], v136, s[24:25] sc1
  s_waitcnt vmcnt(0)
  s_branch SL_72
SX_73:
  global_load_dwordx4 v[24:27], v129, s[24:25] sc1
  global_load_dwordx4 v[28:31], v130, s[24:25] sc1
  global_load_dwordx4 v[32:35], v131, s[24:25] sc1
  global_load_dwordx4 v[36:39], v132, s[24:25] sc1
  v_and_b32 v40, s57, v40
  v_bfi_b32 v41, s39, v16, v41
  v_mov_b32 v57, v40
  s_nop 1
  v_max_f32_dpp v57, v57, v57 row_ror:8 row_mask:0xf bank_mask:0xf
  s_nop 1
  v_max_f32_dpp v57, v57, v57 row_ror:4 row_mask:0xf bank_mask:0xf
  s_nop 1
  v_max_f32_dpp v57, v57, v57 row_ror:2 row_mask:0xf bank_mask:0xf
  s_nop 1
  v_max_f32_dpp v57, v57, v57 row_ror:1 row_mask:0xf bank_mask:0xf
  v_sub_f32 v57, v40, v57
  v_mul_f32 v57, s56, v57
  v_exp_f32 v57, v57
  s_nop 0
  v_mul_f32 v58, v57, v41
  s_nop 1
  v_add_f32_dpp v58, v58, v58 row_ror:8 row_mask:0xf bank_mask:0xf
  s_nop 1
  v_add_f32_dpp v58, v58, v58 row_ror:4 row_mask:0xf bank_mask:0xf
  s_nop 1
  v_add_f32_dpp v58, v58, v58 row_ror:2 row_mask:0xf bank_mask:0xf
  s_nop 1
  v_add_f32_dpp v58, v58, v58 row_ror:1 row_mask:0xf bank_mask:0xf
  v_rcp_f32 v58, v58
  s_nop 0
  v_mul_f32 v57, v57, v58
  s_lshr_b32 s41, s31, 1
  s_lshl_b32 s41, s41, 6
  v_lshlrev_b32 v58, 2, v2
  v_add_u32 v58, s41, v58
  v_add_u32 v59, 0, v58
  ds_bpermute_b32 v52, v59, v57
  v_add_u32 v59, 16, v58
  ds_bpermute_b32 v53, v59, v57
  v_add_u32 v59, 32, v58
  ds_bpermute_b32 v54, v59, v57
  v_add_u32 v59, 48, v58
  ds_bpermute_b32 v55, v59, v57
  s_add_u32 s41, s38, 144
  s_cmp_ge_i32 s60, s41
  s_cbranch_scc1 WLX_75
WL_74:
  ds_read_b32 v21, v19
  s_waitcnt lgkmcnt(0)
  v_readfirstlane_b32 s60, v21
  s_nop 0
  s_cmp_ge_i32 s60, s41
  s_cbranch_scc1 WLX_75
  s_cmp_eq_u32 s40, 0
  s_cbranch_scc1 WLX_75
  s_sub_u32 s40, s40, 1
  s_branch WL_74
WLX_75:
  ds_read_b64_tr_b16 v[64:65], v20 offset:8192
  ds_read_b64_tr_b16 v[66:67], v20 offset:10240
  ds_read_b64_tr_b16 v[72:73], v20 offset:12288
  ds_read_b64_tr_b16 v[74:75], v20 offset:14336
  ds_read_b64_tr_b16 v[80:81], v20 offset:16384
  ds_read_b64_tr_b16 v[82:83], v20 offset:18432
  ds_read_b64_tr_b16 v[88:89], v20 offset:20480
  ds_read_b64_tr_b16 v[90:91], v20 offset:22528
QL_76:
  s_waitcnt vmcnt(0)
  v_xor_b32 v40, v24, v12
  v_bitop3_b32 v40, v25, v13, v40 bitop3:0xBE
  v_bitop3_b32 v40, v26, v14, v40 bitop3:0xBE
  v_bitop3_b32 v40, v27, v15, v40 bitop3:0xBE
  v_xor_b32 v41, v28, v12
  v_bitop3_b32 v41, v29, v13, v41 bitop3:0xBE
  v_bitop3_b32 v41, v30, v14, v41 bitop3:0xBE
  v_bitop3_b32 v41, v31, v15, v41 bitop3:0xBE
  v_xor_b32 v42, v32, v12
  v_bitop3_b32 v42, v33, v13, v42 bitop3:0xBE
  v_bitop3_b32 v42, v34, v14, v42 bitop3:0xBE
  v_bitop3_b32 v42, v35, v15, v42 bitop3:0xBE
  v_xor_b32 v43, v36, v12
  v_bitop3_b32 v43, v37, v13, v43 bitop3:0xBE
  v_bitop3_b32 v43, v38, v14, v43 bitop3:0xBE
  v_bitop3_b32 v43, v39, v15, v43 bitop3:0xBE
  v_or3_b32 v21, v40, v41, v42
  v_or_b32 v21, v21, v43
  v_and_b32 v21, s39, v21
  v_cmp_ne_u32 vcc, 0, v21
  s_cbranch_vccz QX_77
  s_mov_b32 s46, 0
  v_and_b32 v40, s39, v40
  v_cmp_ne_u32 vcc, 0, v40
  s_nop 0
  s_cmp_lg_u64 vcc, 0
  s_cselect_b32 s47, 1, 0
  s_or_b32 s46, s46, s47
  v_and_b32 v41, s39, v41
  v_cmp_ne_u32 vcc, 0, v41
  s_nop 0
  s_cmp_lg_u64 vcc, 0
  s_cselect_b32 s47, 2, 0
  s_or_b32 s46, s46, s47
  v_and_b32 v42, s39, v42
  v_cmp_ne_u32 vcc, 0, v42
  s_nop 0
  s_cmp_lg_u64 vcc, 0
  s_cselect_b32 s47, 4, 0
  s_or_b32 s46, s46, s47
  v_and_b32 v43, s39, v43
  v_cmp_ne_u32 vcc, 0, v43
  s_nop 0
  s_cmp_lg_u64 vcc, 0
  s_cselect_b32 s47, 8, 0
  s_or_b32 s46, s46, s47
  s_cmp_eq_u32 s40, 0
  s_cbranch_scc1 QX_77
  s_sub_u32 s40, s40, 1
  s_sleep 2
  s_bitcmp1_b32 s46, 0
  s_cbranch_scc0 QS_78
  global_load_dwordx4 v[24:27], v129, s[24:25] sc1
QS_78:
  s_bitcmp1_b32 s46, 1
  s_cbranch_scc0 QS_79
  global_load_dwordx4 v[28:31], v130, s[24:25] sc1
QS_79:
  s_bitcmp1_b32 s46, 2
  s_cbranch_scc0 QS_80
  global_load_dwordx4 v[32:35], v131, s[24:25] sc1
QS_80:
  s_bitcmp1_b32 s46, 3
  s_cbranch_scc0 QS_81
  global_load_dwordx4 v[36:39], v132, s[24:25] sc1
QS_81:
  s_branch QL_76
QX_77:
  v_bfi_b32 v24, s39, v16, v24
  v_bfi_b32 v25, s39, v16, v25
  v_bfi_b32 v26, s39, v16, v26
  v_bfi_b32 v27, s39, v16, v27
  v_bfi_b32 v28, s39, v16, v28
  v_bfi_b32 v29, s39, v16, v29
  v_bfi_b32 v30, s39, v16, v30
  v_bfi_b32 v31, s39, v16, v31
  v_bfi_b32 v32, s39, v16, v32
  v_bfi_b32 v33, s39, v16, v33
  v_bfi_b32 v34, s39, v16, v34
  v_bfi_b32 v35, s39, v16, v35
  v_bfi_b32 v36, s39, v16, v36
  v_bfi_b32 v37, s39, v16, v37
  v_bfi_b32 v38, s39, v16, v38
  v_bfi_b32 v39, s39, v16, v39
  s_waitcnt lgkmcnt(0)
  v_mul_f32 v24, v24, v52
  v_mul_f32 v25, v25, v52
  v_mul_f32 v26, v26, v52
  v_mul_f32 v27, v27, v52
  v_fma_f32 v24, v28, v53, v24
  v_fma_f32 v25, v29, v53, v25
  v_fma_f32 v26, v30, v53, v26
  v_fma_f32 v27, v31, v53, v27
  v_fma_f32 v24, v32, v54, v24
  v_fma_f32 v25, v33, v54, v25
  v_fma_f32 v26, v34, v54, v26
  v_fma_f32 v27, v35, v54, v27
  v_fma_f32 v24, v36, v55, v24
  v_fma_f32 v25, v37, v55, v25
  v_fma_f32 v26, v38, v55, v26
  v_fma_f32 v27, v39, v55, v27
  v_permlane16_swap_b32 v24, v25
  s_nop 0
  v_permlane16_swap_b32 v26, v27
  v_add_f32 v24, v24, v25
  v_add_f32 v26, v26, v27
  s_nop 1
  v_permlane32_swap_b32 v24, v26
  v_add_f32 v24, v24, v26
  v_cvt_pk_bf16_f32 v24, v24, v24
  ds_write_b16 v133, v24
  s_waitcnt lgkmcnt(0)
  s_barrier
  ds_read_b128 v[68:71], v134 offset:0
  ds_read_b128 v[76:79], v134 offset:64
  ds_read_b128 v[84:87], v134 offset:128
  ds_read_b128 v[92:95], v134 offset:192
  s_waitcnt lgkmcnt(3)
  v_mfma_f32_16x16x32_bf16 v[24:27], v[64:67], v[68:71], 0
  s_waitcnt lgkmcnt(2)
  v_mfma_f32_16x16x32_bf16 v[24:27], v[72:75], v[76:79], v[24:27]
  s_waitcnt lgkmcnt(1)
  v_mfma_f32_16x16x32_bf16 v[24:27], v[80:83], v[84:87], v[24:27]
  s_waitcnt lgkmcnt(0)
  v_mfma_f32_16x16x32_bf16 v[24:27], v[88:91], v[92:95], v[24:27]
  s_nop 7
  v_bfi_b32 v24, s39, v12, v24
  v_bfi_b32 v25, s39, v13, v25
  v_bfi_b32 v26, s39, v14, v26
  v_bfi_b32 v27, s39, v15, v27
  s_mov_b64 exec, s[54:55]
  global_store_dwordx4 v135, v[24:27], s[24:25] sc1
  s_mov_b64 exec, -1
  s_branch CEND_71
FIN2_70:
  s_cmp_lg_u32 s31, 0
  s_cbranch_scc1 CEND_71
  s_cmp_ge_u32 s52, 28
  s_cbranch_scc1 CEND_71
  global_load_ushort v11, v137, s[4:5]
  v_add_u32 v4, 262144, v138
  v_mov_b32 v36, 0
  v_mov_b32 v37, 0
  v_mov_b32 v38, 0
  v_mov_b32 v39, 0
PL_82:
  global_load_dwordx4 v[24:27], v4, s[24:25] sc1
  global_load_dwordx4 v[28:31], v4, s[24:25] offset:1024 sc1
  global_load_dwordx4 v[32:35], v4, s[24:25] offset:2048 sc1
  s_mov_b32 exec_hi, 0
  global_load_dwordx4 v[36:39], v4, s[24:25] offset:3072 sc1
  s_mov_b64 exec, -1
PC_84:
  s_waitcnt vmcnt(0)
  v_xor_b32 v40, v24, v12
  v_bitop3_b32 v40, v25, v13, v40 bitop3:0xBE
  v_bitop3_b32 v40, v26, v14, v40 bitop3:0xBE
  v_bitop3_b32 v40, v27, v15, v40 bitop3:0xBE
  v_bitop3_b32 v40, v28, v12, v40 bitop3:0xBE
  v_bitop3_b32 v40, v29, v13, v40 bitop3:0xBE
  v_bitop3_b32 v40, v30, v14, v40 bitop3:0xBE
  v_bitop3_b32 v40, v31, v15, v40 bitop3:0xBE
  v_bitop3_b32 v40, v32, v12, v40 bitop3:0xBE
  v_bitop3_b32 v40, v33, v13, v40 bitop3:0xBE
  v_bitop3_b32 v40, v34, v14, v40 bitop3:0xBE
  v_bitop3_b32 v40, v35, v15, v40 bitop3:0xBE
  s_mov_b32 exec_hi, 0
  v_bitop3_b32 v40, v36, v12, v40 bitop3:0xBE
  v_bitop3_b32 v40, v37, v13, v40 bitop3:0xBE
  v_bitop3_b32 v40, v38, v14, v40 bitop3:0xBE
  v_bitop3_b32 v40, v39, v15, v40 bitop3:0xBE
  s_mov_b64 exec, -1
  v_and_b32 v40, s39, v40
  v_cmp_ne_u32 vcc, 0, v40
  s_cbranch_vccz PX_83
  s_cmp_eq_u32 s40, 0
  s_cbranch_scc1 PX_83
  s_sub_u32 s40, s40, 1
  s_sleep 8
  s_branch PL_82
PX_83:
  v_bfi_b32 v24, s39, v16, v24
  v_bfi_b32 v25, s39, v16, v25
  v_bfi_b32 v26, s39, v16, v26
  v_bfi_b32 v27, s39, v16, v27
  v_bfi_b32 v28, s39, v16, v28
  v_bfi_b32 v29, s39, v16, v29
  v_bfi_b32 v30, s39, v16, v30
  v_bfi_b32 v31, s39, v16, v31
  v_bfi_b32 v32, s39, v16, v32
  v_bfi_b32 v33, s39, v16, v33
  v_bfi_b32 v34, s39, v16, v34
  v_bfi_b32 v35, s39, v16, v35
  v_bfi_b32 v36, s39, v16, v36
  v_bfi_b32 v37, s39, v16, v37
  v_bfi_b32 v38, s39, v16, v38
  v_bfi_b32 v39, s39, v16, v39
  v_add_f32 v24, v24, v28
  v_add_f32 v32, v32, v36
  v_add_f32 v25, v25, v29
  v_add_f32 v33, v33, v37
  v_add_f32 v26, v26, v30
  v_add_f32 v34, v34, v38
  v_add_f32 v27, v27, v31
  v_add_f32 v35, v35, v39
  v_add_f32 v24, v24, v32
  v_add_f32 v25, v25, v33
  v_add_f32 v26, v26, v34
  v_add_f32 v27, v27, v35
  v_add_f32_dpp v24, v24, v24 row_ror:8 row_mask:0xf bank_mask:0xf
  v_add_f32_dpp v25, v25, v25 row_ror:8 row_mask:0xf bank_mask:0xf
  v_add_f32_dpp v26, v26, v26 row_ror:8 row_mask:0xf bank_mask:0xf
  v_add_f32_dpp v27, v27, v27 row_ror:8 row_mask:0xf bank_mask:0xf
  v_permlane16_swap_b32 v24, v25
  s_nop 0
  v_permlane16_swap_b32 v26, v27
  v_add_f32 v24, v24, v25
  v_add_f32 v26, v26, v27
  s_nop 1
  v_permlane32_swap_b32 v24, v26
  v_add_f32 v24, v24, v26
  v_cvt_pk_bf16_f32 v10, v24, v24
  v_and_b32 v10, s57, v10
  v_mul_f32 v5, 0xbfb8aa3b, v10
  v_exp_f32 v5, v5
  s_nop 0
  v_add_f32 v5, 1.0, v5
  v_rcp_f32 v5, v5
  s_nop 0
  v_mul_f32 v10, v10, v5
  v_cvt_pk_bf16_f32 v10, v10, v10
  v_and_b32 v10, s57, v10
  v_lshlrev_b32 v11, 16, v11
  v_add_u32 v4, 393216, v138
  s_mov_b32 s42, 0x00ff00ff
  s_mov_b32 s43, 0x00ff00ff
  global_load_dwordx4 v[24:27], v4, s[24:25] sc1
  global_load_dwordx4 v[28:31], v4, s[24:25] offset:1024 sc1
  global_load_dwordx4 v[32:35], v4, s[24:25] offset:2048 sc1
  global_load_dwordx4 v[36:39], v4, s[24:25] offset:3072 sc1
QL_85:
  s_waitcnt vmcnt(0)
  v_xor_b32 v40, v24, v12
  v_bitop3_b32 v40, v25, v13, v40 bitop3:0xBE
  v_bitop3_b32 v40, v26, v14, v40 bitop3:0xBE
  v_bitop3_b32 v40, v27, v15, v40 bitop3:0xBE
  v_xor_b32 v41, v28, v12
  v_bitop3_b32 v41, v29, v13, v41 bitop3:0xBE
  v_bitop3_b32 v41, v30, v14, v41 bitop3:0xBE
  v_bitop3_b32 v41, v31, v15, v41 bitop3:0xBE
  v_xor_b32 v42, v32, v12
  v_bitop3_b32 v42, v33, v13, v42 bitop3:0xBE
  v_bitop3_b32 v42, v34, v14, v42 bitop3:0xBE
  v_bitop3_b32 v42, v35, v15, v42 bitop3:0xBE
  v_xor_b32 v43, v36, v12
  v_bitop3_b32 v43, v37, v13, v43 bitop3:0xBE
  v_bitop3_b32 v43, v38, v14, v43 bitop3:0xBE
  v_bitop3_b32 v43, v39, v15, v43 bitop3:0xBE
  v_or3_b32 v21, v40, v41, v42
  v_or_b32 v21, v21, v43
  v_and_b32 v21, s39, v21
  v_cmp_ne_u32 vcc, 0, v21
  s_cbranch_vccz QX_86
  s_mov_b32 s46, 0
  v_and_b32 v40, s39, v40
  v_cmp_ne_u32 vcc, 0, v40
  s_nop 0
  s_cmp_lg_u64 vcc, 0
  s_cselect_b32 s47, 1, 0
  s_or_b32 s46, s46, s47
  v_and_b32 v41, s39, v41
  v_cmp_ne_u32 vcc, 0, v41
  s_nop 0
  s_cmp_lg_u64 vcc, 0
  s_cselect_b32 s47, 2, 0
  s_or_b32 s46, s46, s47
  v_and_b32 v42, s39, v42
  v_cmp_ne_u32 vcc, 0, v42
  s_nop 0
  s_cmp_lg_u64 vcc, 0
  s_cselect_b32 s47, 4, 0
  s_or_b32 s46, s46, s47
  v_and_b32 v43, s39, v43
  v_cmp_ne_u32 vcc, 0, v43
  s_nop 0
  s_cmp_lg_u64 vcc, 0
  s_cselect_b32 s47, 8, 0
  s_or_b32 s46, s46, s47
  s_cmp_eq_u32 s40, 0
  s_cbranch_scc1 QX_86
  s_sub_u32 s40, s40, 1
  s_bitcmp1_b32 s46, 0
  s_cbranch_scc0 QS_87
  global_load_dwordx4 v[24:27], v4, s[24:25] sc1
QS_87:
  s_bitcmp1_b32 s46, 1
  s_cbranch_scc0 QS_88
  global_load_dwordx4 v[28:31], v4, s[24:25] offset:1024 sc1
QS_88:
  s_bitcmp1_b32 s46, 2
  s_cbranch_scc0 QS_89
  global_load_dwordx4 v[32:35], v4, s[24:25] offset:2048 sc1
QS_89:
  s_bitcmp1_b32 s46, 3
  s_cbranch_scc0 QS_90
  global_load_dwordx4 v[36:39], v4, s[24:25] offset:3072 sc1
QS_90:
  s_branch QL_85
QX_86:
  v_bfi_b32 v24, s39, v16, v24
  v_bfi_b32 v25, s39, v16, v25
  v_bfi_b32 v26, s39, v16, v26
  v_bfi_b32 v27, s39, v16, v27
  v_bfi_b32 v28, s39, v16, v28
  v_bfi_b32 v29, s39, v16, v29
  v_bfi_b32 v30, s39, v16, v30
  v_bfi_b32 v31, s39, v16, v31
  v_bfi_b32 v32, s39, v16, v32
  v_bfi_b32 v33, s39, v16, v33
  v_bfi_b32 v34, s39, v16, v34
  v_bfi_b32 v35, s39, v16, v35
  v_bfi_b32 v36, s39, v16, v36
  v_bfi_b32 v37, s39, v16, v37
  v_bfi_b32 v38, s39, v16, v38
  v_bfi_b32 v39, s39, v16, v39
  v_add_f32 v24, v24, v28
  v_add_f32 v32, v32, v36
  v_add_f32 v25, v25, v29
  v_add_f32 v33, v33, v37
  v_add_f32 v26, v26, v30
  v_add_f32 v34, v34, v38
  v_add_f32 v27, v27, v31
  v_add_f32 v35, v35, v39
  v_add_f32 v24, v24, v32
  v_add_f32 v25, v25, v33
  v_add_f32 v26, v26, v34
  v_add_f32 v27, v27, v35
  v_add_f32_dpp v24, v24, v24 row_ror:8 row_mask:0xf bank_mask:0xf
  v_add_f32_dpp v25, v25, v25 row_ror:8 row_mask:0xf bank_mask:0xf
  v_add_f32_dpp v26, v26, v26 row_ror:8 row_mask:0xf bank_mask:0xf
  v_add_f32_dpp v27, v27, v27 row_ror:8 row_mask:0xf bank_mask:0xf
  v_permlane16_swap_b32 v24, v25
  s_nop 0
  v_permlane16_swap_b32 v26, v27
  v_add_f32 v24, v24, v25
  v_add_f32 v26, v26, v27
  s_nop 1
  v_permlane32_swap_b32 v24, v26
  v_add_f32 v24, v24, v26
  v_cvt_pk_bf16_f32 v5, v24, v24
  v_and_b32 v5, s57, v5
  v_mul_f32 v5, v5, v10
  v_cvt_pk_bf16_f32 v5, v5, v5
  v_and_b32 v5, s57, v5
  v_add_f32 v5, v5, v11
  v_cvt_pk_bf16_f32 v5, v5, v5
  s_mov_b64 exec, s[42:43]
  global_store_short v137, v5, s[22:23]
  s_mov_b64 exec, -1
  s_cmp_lg_u32 s52, 0
  s_cbranch_scc1 CEND_71
  v_mov_b32 v4, 0
  v_mov_b32 v5, s32
  s_mov_b64 exec, 1
  global_store_dword v4, v5, s[24:25] sc1
  s_mov_b64 exec, -1
CEND_71:
  s_endpgm
L_exit:
  s_endpgm
.section .rodata,"a"
.p2align 6
.amdhsa_kernel recurrent_scan__sliding_block_cached__geglu_ffn__decode_kernel
  .amdhsa_next_free_vgpr 256
  .amdhsa_next_free_sgpr 102
  .amdhsa_accum_offset 256
  .amdhsa_group_segment_fixed_size 0
  .amdhsa_kernarg_size 96
  .amdhsa_user_sgpr_count 2
  .amdhsa_user_sgpr_kernarg_segment_ptr 1
  .amdhsa_system_sgpr_workgroup_id_x 1
  .amdhsa_float_denorm_mode_32 3
.end_amdhsa_kernel
```
